```python
import torch

def _softmax(x, axis=-1):
    return torch.softmax(x, dim=axis)
def _gelu(x):
    return torch.nn.functional.gelu(x, approximate="tanh")
def _silu(x):
    return torch.nn.functional.silu(x)
def _sigmoid(x):
    return torch.sigmoid(x)
def _layernorm(x, axis=-1, eps=1e-5):
    m = x.mean(dim=axis, keepdim=True)
    v = x.var(dim=axis, keepdim=True, unbiased=False)
    return (x - m) / torch.sqrt(v + eps)
def _scatter_add(tgt, idx, src, axis=0):
    return tgt.clone().index_add_(axis, idx, src)
def _segment_sum(src, seg, n):
    out = torch.zeros((n,) + src.shape[1:], dtype=src.dtype)
    return out.index_add_(0, seg, src)
def _pad(x, pw):
    flat = tuple(v for pair in reversed(pw) for v in pair)
    return torch.nn.functional.pad(x, flat)

kernel_name = 'standalone__mha_softmax__near_ridge'

def setup_inputs():

    _w = (lambda a: (lambda t: t.to(torch.bfloat16) if t.is_floating_point() else t)(torch.as_tensor(a)))
    B, H, Sq, Sk, D = 16, 32, 768, 512, 128
    return {
        "q": _w((lambda *s: torch.randn(*s, dtype=torch.bfloat16) * 0.8)(B, H, Sq, D)),
        "k": _w((lambda *s: torch.randn(*s, dtype=torch.bfloat16) * 0.8)(B, H, Sk, D)),
        "v": _w((lambda *s: torch.randn(*s, dtype=torch.bfloat16) * 0.05)(B, H, Sk, D)),
    }

def reference(q, k, v):
    scale = q.shape[-1] ** -0.5
    scores = torch.einsum("bhqd,bhkd->bhqk", q, k) * scale
    p = _softmax(scores, axis=-1)
    return torch.einsum("bhqk,bhkd->bhqd", p, v)
```

```asm
; @launch grid=(256,1,1) block=(256,1,1) lds=163840

.amdgcn_target "amdgcn-amd-amdhsa--gfx950"
.text
.globl standalone__mha_softmax__near_ridge_kernel
.p2align 8
.type standalone__mha_softmax__near_ridge_kernel,@function
standalone__mha_softmax__near_ridge_kernel:
  s_cmp_ge_u32 s2, 256
  s_cbranch_scc1 L_end
  s_load_dwordx8 s[4:11], s[0:1], 0
  s_load_dwordx4 s[12:15], s[0:1], 32
  v_lshrrev_b32 v1, 6, v0
  v_and_b32 v0, 63, v0
  v_readfirstlane_b32 s43, v1
  v_and_b32 v36, 15, v0
  v_lshrrev_b32 v37, 4, v0
  v_lshrrev_b32 v38, 2, v0
  s_lshr_b32 s65, s43, 1
  s_and_b32 s66, s43, 1
  s_lshl_b32 s64, s66, 12
  s_lshl_b32 s44, s65, 16
  s_add_u32 s44, s44, s64
  s_lshr_b32 s67, 15, s65
  v_add_u32 v39, 0, v37
  v_and_b32 v39, s67, v39
  v_lshlrev_b32 v39, s65, v39
  v_xor_b32 v39, v39, v36
  v_lshlrev_b32 v39, 4, v39
  v_lshl_add_u32 v14, v37, 8, v39
  v_add_u32 v39, 4, v37
  v_and_b32 v39, s67, v39
  v_lshlrev_b32 v39, s65, v39
  v_xor_b32 v39, v39, v36
  v_lshlrev_b32 v39, 4, v39
  v_lshl_add_u32 v15, v37, 8, v39
  v_add_u32 v39, 8, v37
  v_and_b32 v39, s67, v39
  v_lshlrev_b32 v39, s65, v39
  v_xor_b32 v39, v39, v36
  v_lshlrev_b32 v39, 4, v39
  v_lshl_add_u32 v16, v37, 8, v39
  v_add_u32 v39, 12, v37
  v_and_b32 v39, s67, v39
  v_lshlrev_b32 v39, s65, v39
  v_xor_b32 v39, v39, v36
  v_lshlrev_b32 v39, 4, v39
  v_lshl_add_u32 v17, v37, 8, v39
  v_lshrrev_b32 v39, 3, v0
  v_and_b32 v40, 6, v39
  v_and_b32 v41, 7, v0
  v_xor_b32 v40, v40, v41
  v_lshlrev_b32 v40, 4, v40
  v_lshl_add_u32 v48, v39, 8, v40
  v_add_u32 v49, 1024, v48
  s_lshl_b32 s81, s43, 14
  s_lshl_b32 s80, s43, 13
  s_add_u32 s80, s80, 131072
  s_lshl_b32 s82, s65, 16
  s_lshl_b32 s66, s64, 1
  s_add_u32 s82, s82, s66
  s_add_u32 s82, s82, 49152
  s_and_b32 s47, s2, 7
  s_lshr_b32 s46, s2, 3
  s_mul_i32 s65, s46, 43691
  s_lshr_b32 s65, s65, 17
  s_lshl_b32 s66, s47, 6
  s_add_u32 s65, s65, s66
  s_lshl_b32 s49, s65, 17
  s_mul_i32 s66, s47, 192
  s_add_u32 s66, s66, s46
  s_lshl_b32 s48, s66, 16
  s_cmp_lt_u32 s46, 192
  s_cselect_b32 s49, s49, 1073741824
  s_cselect_b32 s48, s48, 1073741824
  s_waitcnt lgkmcnt(0)
  s_mov_b32 s16, s4
  s_mov_b32 s17, s5
  s_mov_b32 s18, 100663296
  s_mov_b32 s19, 0x00020000
  s_cmp_ge_u32 s43, 2
  s_cselect_b32 s20, s8, s6
  s_cselect_b32 s21, s9, s7
  s_mov_b32 s22, 0x4000000
  s_mov_b32 s23, 0x00020000
  s_add_u32 s45, s49, s64
  s_add_u32 m0, s44, 0
  s_nop 0
  buffer_load_dwordx4 v14, s[20:23], s45 offen offset:0 lds
  buffer_load_dwordx4 v15, s[20:23], s45 offen offset:1024 lds
  buffer_load_dwordx4 v16, s[20:23], s45 offen offset:2048 lds
  buffer_load_dwordx4 v17, s[20:23], s45 offen offset:3072 lds
  s_add_u32 s67, s48, s81
  s_add_u32 m0, s80, 0
  s_nop 0
  buffer_load_dwordx4 v48, s[16:19], s67 offen offset:0 nt lds
  buffer_load_dwordx4 v49, s[16:19], s67 offen offset:1024 nt lds
  s_add_u32 m0, s80, 1920
  s_nop 0
  buffer_load_dwordx4 v48, s[16:19], s67 offen offset:128 nt lds
  buffer_load_dwordx4 v49, s[16:19], s67 offen offset:1152 nt lds
  s_add_u32 s67, s67, 4096
  s_add_u32 m0, s80, 4096
  s_nop 0
  buffer_load_dwordx4 v48, s[16:19], s67 offen offset:0 nt lds
  buffer_load_dwordx4 v49, s[16:19], s67 offen offset:1024 nt lds
  s_add_u32 m0, s80, 6016
  s_nop 0
  buffer_load_dwordx4 v48, s[16:19], s67 offen offset:128 nt lds
  buffer_load_dwordx4 v49, s[16:19], s67 offen offset:1152 nt lds
  s_add_u32 s67, s67, 4096
  s_add_u32 m0, s82, 0
  s_nop 0
  buffer_load_dwordx4 v48, s[16:19], s67 offen offset:0 nt lds
  buffer_load_dwordx4 v49, s[16:19], s67 offen offset:1024 nt lds
  s_add_u32 m0, s82, 1920
  s_nop 0
  buffer_load_dwordx4 v48, s[16:19], s67 offen offset:128 nt lds
  buffer_load_dwordx4 v49, s[16:19], s67 offen offset:1152 nt lds
  s_getpc_b64 s[84:85]
L_pf:
  s_lshl_b32 s83, s43, 13
  v_lshlrev_b32 v51, 6, v0
  v_add_u32 v51, s83, v51
  v_min_u32 v18, L_end-L_pf-4, v51
  v_mov_b32 v55, s85
  v_add_co_u32 v54, vcc, s84, v18
  s_nop 1
  v_addc_co_u32 v55, vcc, 0, v55, vcc
  global_load_dword v1, v[54:55], off
  v_add_u32 v51, 0x1000, v51
  v_min_u32 v18, L_end-L_pf-4, v51
  v_mov_b32 v55, s85
  v_add_co_u32 v54, vcc, s84, v18
  s_nop 1
  v_addc_co_u32 v55, vcc, 0, v55, vcc
  global_load_dword v1, v[54:55], off
  v_or_b32 v39, 0, v37
  v_xor_b32 v39, v39, v36
  v_lshlrev_b32 v39, 4, v39
  v_lshl_add_u32 v2, v36, 8, v39
  v_or_b32 v39, 4, v37
  v_xor_b32 v39, v39, v36
  v_lshlrev_b32 v39, 4, v39
  v_lshl_add_u32 v3, v36, 8, v39
  v_or_b32 v39, 8, v37
  v_xor_b32 v39, v39, v36
  v_lshlrev_b32 v39, 4, v39
  v_lshl_add_u32 v4, v36, 8, v39
  v_or_b32 v39, 12, v37
  v_xor_b32 v39, v39, v36
  v_lshlrev_b32 v39, 4, v39
  v_lshl_add_u32 v5, v36, 8, v39
  v_and_b32 v40, 7, v38
  v_and_b32 v41, 3, v0
  v_lshlrev_b32 v41, 3, v41
  v_lshl_add_u32 v41, v38, 8, v41
  v_add_u32 v41, 0x10000, v41
  v_xor_b32 v39, 0, v40
  v_lshl_add_u32 v6, v39, 5, v41
  v_xor_b32 v39, 1, v40
  v_lshl_add_u32 v7, v39, 5, v41
  v_xor_b32 v39, 2, v40
  v_lshl_add_u32 v8, v39, 5, v41
  v_xor_b32 v39, 3, v40
  v_lshl_add_u32 v9, v39, 5, v41
  v_xor_b32 v39, 4, v40
  v_lshl_add_u32 v10, v39, 5, v41
  v_xor_b32 v39, 5, v40
  v_lshl_add_u32 v11, v39, 5, v41
  v_xor_b32 v39, 6, v40
  v_lshl_add_u32 v12, v39, 5, v41
  v_xor_b32 v39, 7, v40
  v_lshl_add_u32 v13, v39, 5, v41
  v_and_b32 v40, 6, v36
  v_and_b32 v41, 7, v36
  v_lshrrev_b32 v42, 3, v36
  v_lshlrev_b32 v41, 7, v41
  v_lshl_add_u32 v41, v42, 10, v41
  v_or_b32 v39, 0, v37
  v_xor_b32 v39, v39, v40
  v_lshl_add_u32 v39, v39, 4, v41
  v_add_u32 v52, s80, v39
  v_add_u32 v58, s82, v39
  v_or_b32 v39, 4, v37
  v_xor_b32 v39, v39, v40
  v_lshl_add_u32 v39, v39, 4, v41
  v_add_u32 v53, s80, v39
  v_add_u32 v59, s82, v39
  v_lshlrev_b32 v39, 4, v0
  v_add_u32 v19, s81, v39
  v_mul_u32_u24 v39, 272, v36
  v_lshl_add_u32 v39, v37, 3, v39
  v_add_u32 v56, s80, v39
  v_mul_u32_u24 v39, 272, v37
  v_lshl_add_u32 v39, v36, 4, v39
  v_add_u32 v57, s80, v39
  v_and_b32 v39, 3, v0
  v_cmp_eq_u32 vcc, 0, v39
  v_mov_b32 v40, 0x3f803f80
  v_mov_b32 v39, 0
  v_cndmask_b32 v32, v39, v40, vcc
  v_cndmask_b32 v33, v39, v40, vcc
  v_cndmask_b32 v34, v39, v40, vcc
  v_cndmask_b32 v35, v39, v40, vcc
  v_mov_b32 v64, 0
  v_mov_b32 v65, 0
  v_mov_b32 v66, 0
  v_mov_b32 v67, 0
  v_mov_b32 v68, 0
  v_mov_b32 v69, 0
  v_mov_b32 v70, 0
  v_mov_b32 v71, 0
  v_mov_b32 v72, 0
  v_mov_b32 v73, 0
  v_mov_b32 v74, 0
  v_mov_b32 v75, 0
  v_mov_b32 v76, 0
  v_mov_b32 v77, 0
  v_mov_b32 v78, 0
  v_mov_b32 v79, 0
  v_mov_b32 v112, 0
  v_mov_b32 v113, 0
  v_mov_b32 v114, 0
  v_mov_b32 v115, 0
  v_mov_b32 v116, 0
  v_mov_b32 v117, 0
  v_mov_b32 v118, 0
  v_mov_b32 v119, 0
  s_mov_b32 s40, 0x3e0293ee
  s_mov_b32 s41, 0xbe0293ee
  s_mov_b32 s42, 0x4b800000
  s_mov_b32 s54, 0
  s_mov_b32 s55, 0
  s_mov_b32 s56, 0
  s_mov_b32 s57, 0
  s_mov_b32 s58, 0
  s_mov_b32 s59, 0
  s_mov_b32 s60, 0
  s_mov_b32 s61, 0
  s_mov_b32 s88, 1073741824
  s_mov_b32 s89, 1073741824
  s_mov_b32 s90, 1073741824
  s_mov_b32 s91, 1073741824
  s_mov_b32 s50, 1073741824
  s_mov_b32 s51, 1073741824
  s_mov_b32 s62, 5
  s_mov_b32 s24, s10
  s_mov_b32 s25, s11
  s_mov_b32 s26, 100663296
  s_mov_b32 s27, 0x00020000
  s_mov_b32 s28, s6
  s_mov_b32 s29, s7
  s_mov_b32 s30, 67108864
  s_mov_b32 s31, 0x00020000
  s_mov_b32 s32, s8
  s_mov_b32 s33, s9
  s_mov_b32 s34, 67108864
  s_mov_b32 s35, 0x00020000
  s_mov_b32 s36, s14
  s_mov_b32 s37, s15
  s_mov_b32 s38, 402653184
  s_mov_b32 s39, 0x00020000
  s_waitcnt vmcnt(14)
  s_barrier
  ds_read_b128 a[128:131], v2 offset:0
  ds_read_b128 a[144:147], v2 offset:4096
  ds_read_b128 a[132:135], v3 offset:0
  ds_read_b128 a[148:151], v3 offset:4096
  ds_read_b128 a[136:139], v4 offset:0
  ds_read_b128 a[152:155], v4 offset:4096
  ds_read_b128 a[140:143], v5 offset:0
  ds_read_b128 a[156:159], v5 offset:4096
  s_add_u32 s45, s45, 8192
  s_add_u32 m0, s44, 8192
  s_nop 0
  buffer_load_dwordx4 v14, s[20:23], s45 offen offset:0 lds
  buffer_load_dwordx4 v15, s[20:23], s45 offen offset:1024 lds
  buffer_load_dwordx4 v16, s[20:23], s45 offen offset:2048 lds
  buffer_load_dwordx4 v17, s[20:23], s45 offen offset:3072 lds
  s_waitcnt vmcnt(16)
  ds_read_b128 a[0:3], v52 offset:0
  ds_read_b128 a[4:7], v53 offset:0
  s_waitcnt vmcnt(14)
  ds_read_b128 a[8:11], v52 offset:2048
  ds_read_b128 a[12:15], v53 offset:2048
  ds_read_b64_tr_b16 a[192:193], v6 offset:0
  ds_read_b64_tr_b16 a[194:195], v6 offset:4096
  ds_read_b64_tr_b16 a[196:197], v7 offset:0
  ds_read_b64_tr_b16 a[198:199], v7 offset:4096
  ds_read_b64_tr_b16 a[200:201], v8 offset:0
  ds_read_b64_tr_b16 a[202:203], v8 offset:4096
  ds_read_b64_tr_b16 a[204:205], v9 offset:0
  ds_read_b64_tr_b16 a[206:207], v9 offset:4096
  ds_read_b64_tr_b16 a[208:209], v10 offset:0
  ds_read_b64_tr_b16 a[210:211], v10 offset:4096
  ds_read_b64_tr_b16 a[212:213], v11 offset:0
  ds_read_b64_tr_b16 a[214:215], v11 offset:4096
  ds_read_b64_tr_b16 a[216:217], v12 offset:0
  ds_read_b64_tr_b16 a[218:219], v12 offset:4096
  ds_read_b64_tr_b16 a[220:221], v13 offset:0
  ds_read_b64_tr_b16 a[222:223], v13 offset:4096
  s_add_u32 s67, s67, 4096
  s_add_u32 m0, s82, 4096
  s_nop 0
  buffer_load_dwordx4 v48, s[16:19], s67 offen offset:0 nt lds
  buffer_load_dwordx4 v49, s[16:19], s67 offen offset:1024 nt lds
  s_add_u32 m0, s82, 6016
  s_nop 0
  buffer_load_dwordx4 v48, s[16:19], s67 offen offset:128 nt lds
  buffer_load_dwordx4 v49, s[16:19], s67 offen offset:1152 nt lds
  s_waitcnt lgkmcnt(15)
  v_mfma_f32_16x16x32_bf16 v[96:99], a[128:131], a[0:3], 0
  v_mfma_f32_16x16x32_bf16 v[96:99], a[132:135], a[4:7], v[96:99]
  v_mfma_f32_16x16x32_bf16 v[96:99], a[136:139], a[8:11], v[96:99]
  v_mfma_f32_16x16x32_bf16 v[96:99], a[140:143], a[12:15], v[96:99]
  s_waitcnt vmcnt(16)
  ds_read_b128 a[16:19], v52 offset:4096
  ds_read_b128 a[20:23], v53 offset:4096
  s_waitcnt vmcnt(14)
  ds_read_b128 a[24:27], v52 offset:6144
  ds_read_b128 a[28:31], v53 offset:6144
  v_mfma_f32_16x16x32_bf16 v[100:103], a[156:159], a[12:15], 0
  v_mfma_f32_16x16x32_bf16 v[100:103], a[152:155], a[8:11], v[100:103]
  v_mfma_f32_16x16x32_bf16 v[100:103], a[148:151], a[4:7], v[100:103]
  v_mfma_f32_16x16x32_bf16 v[100:103], a[144:147], a[0:3], v[100:103]
  s_add_u32 s45, s45, 8192
  s_add_u32 m0, s44, 16384
  s_nop 0
  buffer_load_dwordx4 v14, s[20:23], s45 offen offset:0 lds
  buffer_load_dwordx4 v15, s[20:23], s45 offen offset:1024 lds
  buffer_load_dwordx4 v16, s[20:23], s45 offen offset:2048 lds
  buffer_load_dwordx4 v17, s[20:23], s45 offen offset:3072 lds
  s_waitcnt lgkmcnt(0)
  v_mfma_f32_16x16x32_bf16 v[104:107], a[128:131], a[16:19], 0
  s_mov_b32 s52, s50
  v_max3_f32 v60, v96, v97, v98
  v_max3_f32 v61, v99, v100, v101
  v_mfma_f32_16x16x32_bf16 v[104:107], a[132:135], a[20:23], v[104:107]
  s_mov_b32 s53, s51
  v_max3_f32 v60, v102, v103, v60
  v_max_f32 v60, v60, v61
  v_mfma_f32_16x16x32_bf16 v[104:107], a[136:139], a[24:27], v[104:107]
  s_mov_b32 s50, s48
  s_mov_b32 s51, s49
  v_mov_b32 v61, v60
  v_mfma_f32_16x16x32_bf16 v[104:107], a[140:143], a[28:31], v[104:107]
  s_nop 0
  v_permlane32_swap_b32 v61, v60
  v_max_f32 v60, v60, v61
  v_mov_b32 v61, v60
  v_mfma_f32_16x16x32_bf16 v[108:111], a[156:159], a[28:31], 0
  s_nop 0
  v_permlane16_swap_b32 v61, v60
  v_max_f32 v60, v60, v61
  v_mul_f32 v20, s41, v60
  v_fma_f32 v96, v96, s40, v20
  v_fma_f32 v97, v97, s40, v20
  v_exp_f32 v96, v96
  v_exp_f32 v97, v97
  v_fma_f32 v98, v98, s40, v20
  v_fma_f32 v99, v99, s40, v20
  v_exp_f32 v98, v98
  v_exp_f32 v99, v99
  v_mfma_f32_16x16x32_bf16 v[108:111], a[152:155], a[24:27], v[108:111]
  v_cvt_pk_bf16_f32 v112, v96, v97
  v_fma_f32 v100, v100, s40, v20
  v_exp_f32 v100, v100
  v_mfma_f32_16x16x32_bf16 v[108:111], a[148:151], a[20:23], v[108:111]
  v_cvt_pk_bf16_f32 v113, v98, v99
  v_fma_f32 v101, v101, s40, v20
  v_exp_f32 v101, v101
  v_fma_f32 v102, v102, s40, v20
  v_fma_f32 v103, v103, s40, v20
  v_exp_f32 v102, v102
  v_exp_f32 v103, v103
  v_mfma_f32_16x16x32_bf16 v[108:111], a[144:147], a[16:19], v[108:111]
  s_waitcnt vmcnt(16)
  ds_read_b128 a[32:35], v58 offset:0
  ds_read_b128 a[36:39], v59 offset:0
  s_waitcnt vmcnt(14)
  ds_read_b128 a[40:43], v58 offset:2048
  ds_read_b128 a[44:47], v59 offset:2048
  v_cvt_pk_bf16_f32 v114, v100, v101
  v_cvt_pk_bf16_f32 v115, v102, v103
  s_waitcnt vmcnt(8) lgkmcnt(0)
  s_barrier
  v_mfma_f32_16x16x32_bf16 v[96:99], a[128:131], a[32:35], 0
  ds_read_b128 a[160:163], v2 offset:8192
  ds_read_b64_tr_b16 a[224:225], v6 offset:8192
  s_add_u32 s46, s46, 32
  v_mfma_f32_16x16x32_bf16 v[96:99], a[132:135], a[36:39], v[96:99]
  s_add_u32 s45, s45, 8192
  s_add_u32 m0, s44, 24576
  s_mul_i32 s65, s46, 43691
  v_mfma_f32_16x16x32_bf16 v[96:99], a[136:139], a[40:43], v[96:99]
  ds_read_b64_tr_b16 a[226:227], v6 offset:12288
  s_lshr_b32 s65, s65, 17
  s_lshl_b32 s66, s47, 6
  v_mfma_f32_16x16x32_bf16 v[96:99], a[140:143], a[44:47], v[96:99]
  ds_read_b128 a[176:179], v2 offset:12288
  s_add_u32 s65, s65, s66
  s_lshl_b32 s49, s65, 17
  v_mfma_f32_16x16x32_bf16 v[100:103], a[156:159], a[44:47], 0
  s_mul_i32 s66, s47, 192
  v_max3_f32 v62, v104, v105, v106
  v_max3_f32 v63, v107, v108, v109
  v_mfma_f32_16x16x32_bf16 v[100:103], a[152:155], a[40:43], v[100:103]
  s_add_u32 s66, s66, s46
  v_max3_f32 v62, v110, v111, v62
  v_max_f32 v62, v62, v63
  v_mfma_f32_16x16x32_bf16 v[100:103], a[148:151], a[36:39], v[100:103]
  ds_read_b128 a[164:167], v3 offset:8192
  s_lshl_b32 s48, s66, 16
  v_mov_b32 v63, v62
  v_mfma_f32_16x16x32_bf16 v[100:103], a[144:147], a[32:35], v[100:103]
  s_nop 0
  v_permlane32_swap_b32 v63, v62
  v_mfma_f32_16x16x32_bf16 v[128:131], a[192:195], v[112:115], 0
  s_cmp_lt_u32 s46, 192
  s_cselect_b32 s49, s49, 1073741824
  s_cselect_b32 s48, s48, 1073741824
  v_max_f32 v62, v62, v63
  v_mov_b32 v63, v62
  v_mfma_f32_16x16x32_bf16 v[132:135], a[196:199], v[112:115], 0
  s_nop 0
  v_permlane16_swap_b32 v63, v62
  v_mfma_f32_16x16x32_bf16 v[136:139], a[200:203], v[112:115], 0
  buffer_load_dwordx4 v14, s[20:23], s45 offen offset:0 lds
  buffer_load_dwordx4 v15, s[20:23], s45 offen offset:1024 lds
  buffer_load_dwordx4 v16, s[20:23], s45 offen offset:2048 lds
  buffer_load_dwordx4 v17, s[20:23], s45 offen offset:3072 lds
  v_mfma_f32_16x16x32_bf16 v[140:143], a[204:207], v[112:115], 0
  ds_read_b64_tr_b16 a[228:229], v7 offset:8192
  v_max_f32 v62, v62, v63
  v_mfma_f32_16x16x32_bf16 v[144:147], a[208:211], v[112:115], 0
  v_mul_f32 v21, s41, v62
  v_fma_f32 v104, v104, s40, v21
  v_mfma_f32_16x16x32_bf16 v[148:151], a[212:215], v[112:115], 0
  ds_read_b64_tr_b16 a[230:231], v7 offset:12288
  ds_read_b128 a[180:183], v3 offset:12288
  v_fma_f32 v105, v105, s40, v21
  v_exp_f32 v104, v104
  v_exp_f32 v105, v105
  v_fma_f32 v106, v106, s40, v21
  v_fma_f32 v107, v107, s40, v21
  v_exp_f32 v106, v106
  v_exp_f32 v107, v107
  v_mfma_f32_16x16x32_bf16 v[152:155], a[216:219], v[112:115], 0
  s_waitcnt vmcnt(10)
  ds_read_b128 a[48:51], v58 offset:4096
  ds_read_b128 a[52:55], v59 offset:4096
  s_waitcnt vmcnt(8)
  ds_read_b128 a[56:59], v58 offset:6144
  ds_read_b128 a[60:63], v59 offset:6144
  v_cvt_pk_bf16_f32 v116, v104, v105
  v_fma_f32 v108, v108, s40, v21
  v_exp_f32 v108, v108
  v_mfma_f32_16x16x32_bf16 v[156:159], a[220:223], v[112:115], 0
  v_cvt_pk_bf16_f32 v117, v106, v107
  v_fma_f32 v109, v109, s40, v21
  v_exp_f32 v109, v109
  v_fma_f32 v110, v110, s40, v21
  v_fma_f32 v111, v111, s40, v21
  v_exp_f32 v110, v110
  v_exp_f32 v111, v111
  v_mfma_f32_16x16x32_bf16 v[64:67], v[32:35], v[112:115], 0
  ds_read_b64_tr_b16 a[232:233], v8 offset:8192
  ds_read_b128 a[168:171], v4 offset:8192
  v_cvt_pk_bf16_f32 v118, v108, v109
  v_cvt_pk_bf16_f32 v119, v110, v111
  s_waitcnt lgkmcnt(2)
  v_mfma_f32_16x16x32_bf16 v[104:107], a[128:131], a[48:51], 0
  ds_read_b64_tr_b16 a[234:235], v8 offset:12288
  ds_read_b128 a[184:187], v4 offset:12288
  v_mfma_f32_16x16x32_bf16 v[104:107], a[132:135], a[52:55], v[104:107]
  v_max3_f32 v60, v96, v97, v98
  v_max3_f32 v61, v99, v100, v101
  v_mfma_f32_16x16x32_bf16 v[104:107], a[136:139], a[56:59], v[104:107]
  v_max3_f32 v60, v102, v103, v60
  v_max_f32 v60, v60, v61
  v_mfma_f32_16x16x32_bf16 v[104:107], a[140:143], a[60:63], v[104:107]
  ds_read_b64_tr_b16 a[236:237], v9 offset:8192
  v_mov_b32 v61, v60
  v_mfma_f32_16x16x32_bf16 v[108:111], a[156:159], a[60:63], 0
  s_nop 0
  v_permlane32_swap_b32 v61, v60
  v_mfma_f32_16x16x32_bf16 v[108:111], a[152:155], a[56:59], v[108:111]
  ds_read_b128 a[172:175], v5 offset:8192
  v_max_f32 v60, v60, v61
  v_mfma_f32_16x16x32_bf16 v[108:111], a[148:151], a[52:55], v[108:111]
  ds_read_b64_tr_b16 a[238:239], v9 offset:12288
  v_mov_b32 v61, v60
  v_mfma_f32_16x16x32_bf16 v[108:111], a[144:147], a[48:51], v[108:111]
  s_nop 0
  v_permlane16_swap_b32 v61, v60
  v_mfma_f32_16x16x32_bf16 v[160:163], a[192:195], v[116:119], 0
  ds_read_b128 a[188:191], v5 offset:12288
  v_max_f32 v60, v60, v61
  v_mfma_f32_16x16x32_bf16 v[164:167], a[196:199], v[116:119], 0
  ds_read_b64_tr_b16 a[240:241], v10 offset:8192
  v_mul_f32 v22, s41, v60
  v_mfma_f32_16x16x32_bf16 v[168:171], a[200:203], v[116:119], 0
  s_add_u32 s45, s45, 8192
  s_add_u32 m0, s44, 32768
  s_nop 0
  buffer_load_dwordx4 v14, s[20:23], s45 offen offset:0 lds
  buffer_load_dwordx4 v15, s[20:23], s45 offen offset:1024 lds
  buffer_load_dwordx4 v16, s[20:23], s45 offen offset:2048 lds
  buffer_load_dwordx4 v17, s[20:23], s45 offen offset:3072 lds
  v_mfma_f32_16x16x32_bf16 v[172:175], a[204:207], v[116:119], 0
  ds_read_b64_tr_b16 a[242:243], v10 offset:12288
  v_fma_f32 v96, v96, s40, v22
  v_mfma_f32_16x16x32_bf16 v[176:179], a[208:211], v[116:119], 0
  v_fma_f32 v97, v97, s40, v22
  v_exp_f32 v96, v96
  v_mfma_f32_16x16x32_bf16 v[180:183], a[212:215], v[116:119], 0
  v_exp_f32 v97, v97
  v_fma_f32 v98, v98, s40, v22
  v_fma_f32 v99, v99, s40, v22
  v_exp_f32 v98, v98
  v_exp_f32 v99, v99
  v_mfma_f32_16x16x32_bf16 v[184:187], a[216:219], v[116:119], 0
  ds_read_b64_tr_b16 a[244:245], v11 offset:8192
  v_cvt_pk_bf16_f32 v112, v96, v97
  v_fma_f32 v100, v100, s40, v22
  v_exp_f32 v100, v100
  v_mfma_f32_16x16x32_bf16 v[188:191], a[220:223], v[116:119], 0
  v_cvt_pk_bf16_f32 v113, v98, v99
  v_fma_f32 v101, v101, s40, v22
  v_exp_f32 v101, v101
  v_fma_f32 v102, v102, s40, v22
  v_fma_f32 v103, v103, s40, v22
  v_exp_f32 v102, v102
  v_exp_f32 v103, v103
  v_mfma_f32_16x16x32_bf16 v[68:71], v[32:35], v[116:119], 0
  ds_read_b64_tr_b16 a[246:247], v11 offset:12288
  v_cvt_pk_bf16_f32 v114, v100, v101
  v_cvt_pk_bf16_f32 v115, v102, v103
  s_waitcnt lgkmcnt(4)
  v_mfma_f32_16x16x32_bf16 v[96:99], a[160:163], a[0:3], 0
  ds_read_b64_tr_b16 a[248:249], v12 offset:8192
  v_max3_f32 v62, v104, v105, v106
  v_mfma_f32_16x16x32_bf16 v[96:99], a[164:167], a[4:7], v[96:99]
  v_max3_f32 v63, v107, v108, v109
  v_max3_f32 v62, v110, v111, v62
  v_mfma_f32_16x16x32_bf16 v[96:99], a[168:171], a[8:11], v[96:99]
  v_max_f32 v62, v62, v63
  v_mov_b32 v63, v62
  v_mfma_f32_16x16x32_bf16 v[96:99], a[172:175], a[12:15], v[96:99]
  ds_read_b64_tr_b16 a[250:251], v12 offset:12288
  v_permlane32_swap_b32 v63, v62
  v_mfma_f32_16x16x32_bf16 v[100:103], a[188:191], a[12:15], 0
  v_max_f32 v62, v62, v63
  v_mov_b32 v63, v62
  v_mfma_f32_16x16x32_bf16 v[100:103], a[184:187], a[8:11], v[100:103]
  s_nop 0
  v_permlane16_swap_b32 v63, v62
  v_mfma_f32_16x16x32_bf16 v[100:103], a[180:183], a[4:7], v[100:103]
  v_max_f32 v62, v62, v63
  v_mul_f32 v23, s41, v62
  v_mfma_f32_16x16x32_bf16 v[100:103], a[176:179], a[0:3], v[100:103]
  ds_read_b64_tr_b16 a[252:253], v13 offset:8192
  v_fma_f32 v104, v104, s40, v23
  v_mfma_f32_16x16x32_bf16 v[192:195], a[192:195], v[112:115], 0
  v_fma_f32 v105, v105, s40, v23
  v_exp_f32 v104, v104
  v_mfma_f32_16x16x32_bf16 v[196:199], a[196:199], v[112:115], 0
  ds_read_b64_tr_b16 a[254:255], v13 offset:12288
  v_exp_f32 v105, v105
  v_mfma_f32_16x16x32_bf16 v[200:203], a[200:203], v[112:115], 0
  s_add_u32 s45, s45, 8192
  s_add_u32 m0, s44, 40960
  s_nop 0
  buffer_load_dwordx4 v14, s[20:23], s45 offen offset:0 lds
  buffer_load_dwordx4 v15, s[20:23], s45 offen offset:1024 lds
  buffer_load_dwordx4 v16, s[20:23], s45 offen offset:2048 lds
  buffer_load_dwordx4 v17, s[20:23], s45 offen offset:3072 lds
  v_mfma_f32_16x16x32_bf16 v[204:207], a[204:207], v[112:115], 0
  v_fma_f32 v106, v106, s40, v23
  v_fma_f32 v107, v107, s40, v23
  v_mfma_f32_16x16x32_bf16 v[208:211], a[208:211], v[112:115], 0
  v_exp_f32 v106, v106
  v_mfma_f32_16x16x32_bf16 v[212:215], a[212:215], v[112:115], 0
  v_exp_f32 v107, v107
  v_mfma_f32_16x16x32_bf16 v[216:219], a[216:219], v[112:115], 0
  v_cvt_pk_bf16_f32 v116, v104, v105
  v_fma_f32 v108, v108, s40, v23
  v_exp_f32 v108, v108
  v_mfma_f32_16x16x32_bf16 v[220:223], a[220:223], v[112:115], 0
  v_cvt_pk_bf16_f32 v117, v106, v107
  v_fma_f32 v109, v109, s40, v23
  v_exp_f32 v109, v109
  v_fma_f32 v110, v110, s40, v23
  v_fma_f32 v111, v111, s40, v23
  v_exp_f32 v110, v110
  v_exp_f32 v111, v111
  v_mfma_f32_16x16x32_bf16 v[72:75], v[32:35], v[112:115], 0
  v_cvt_pk_bf16_f32 v118, v108, v109
  v_cvt_pk_bf16_f32 v119, v110, v111
  s_waitcnt vmcnt(12) lgkmcnt(0)
  s_barrier
  v_mfma_f32_16x16x32_bf16 v[104:107], a[160:163], a[16:19], 0
  v_fma_f32 v96, v96, s40, v20
  v_fma_f32 v97, v97, s40, v20
  v_mfma_f32_16x16x32_bf16 v[104:107], a[164:167], a[20:23], v[104:107]
  v_exp_f32 v96, v96
  v_mfma_f32_16x16x32_bf16 v[104:107], a[168:171], a[24:27], v[104:107]
  v_exp_f32 v97, v97
  v_mfma_f32_16x16x32_bf16 v[104:107], a[172:175], a[28:31], v[104:107]
  v_fma_f32 v98, v98, s40, v20
  v_fma_f32 v99, v99, s40, v20
  v_mfma_f32_16x16x32_bf16 v[108:111], a[188:191], a[28:31], 0
  v_exp_f32 v98, v98
  v_mfma_f32_16x16x32_bf16 v[108:111], a[184:187], a[24:27], v[108:111]
  ds_read_b128 a[128:131], v2 offset:16384
  s_add_u32 s45, s45, 8192
  v_mfma_f32_16x16x32_bf16 v[108:111], a[180:183], a[20:23], v[108:111]
  v_exp_f32 v99, v99
  v_mfma_f32_16x16x32_bf16 v[108:111], a[176:179], a[16:19], v[108:111]
  s_add_u32 m0, s44, 49152
  v_cvt_pk_bf16_f32 v112, v96, v97
  v_mfma_f32_16x16x32_bf16 v[224:227], a[192:195], v[116:119], 0
  ds_read_b128 a[144:147], v2 offset:20480
  v_fma_f32 v100, v100, s40, v20
  v_mfma_f32_16x16x32_bf16 v[228:231], a[196:199], v[116:119], 0
  v_exp_f32 v100, v100
  v_mfma_f32_16x16x32_bf16 v[232:235], a[200:203], v[116:119], 0
  buffer_load_dwordx4 v14, s[20:23], s45 offen offset:0 lds
  buffer_load_dwordx4 v15, s[20:23], s45 offen offset:1024 lds
  buffer_load_dwordx4 v16, s[20:23], s45 offen offset:2048 lds
  buffer_load_dwordx4 v17, s[20:23], s45 offen offset:3072 lds
  v_mfma_f32_16x16x32_bf16 v[236:239], a[204:207], v[116:119], 0
  v_cvt_pk_bf16_f32 v113, v98, v99
  v_fma_f32 v101, v101, s40, v20
  v_mfma_f32_16x16x32_bf16 v[240:243], a[208:211], v[116:119], 0
  v_exp_f32 v101, v101
  v_mfma_f32_16x16x32_bf16 v[244:247], a[212:215], v[116:119], 0
  v_fma_f32 v102, v102, s40, v20
  v_fma_f32 v103, v103, s40, v20
  v_mfma_f32_16x16x32_bf16 v[248:251], a[216:219], v[116:119], 0
  v_exp_f32 v102, v102
  v_mfma_f32_16x16x32_bf16 v[252:255], a[220:223], v[116:119], 0
  v_exp_f32 v103, v103
  v_mfma_f32_16x16x32_bf16 v[76:79], v[32:35], v[116:119], 0
  v_cvt_pk_bf16_f32 v114, v100, v101
  v_cvt_pk_bf16_f32 v115, v102, v103
  v_mfma_f32_16x16x32_bf16 v[96:99], a[160:163], a[32:35], 0
  ds_read_b128 a[132:135], v3 offset:16384
  v_fma_f32 v104, v104, s40, v21
  v_mfma_f32_16x16x32_bf16 v[96:99], a[164:167], a[36:39], v[96:99]
  ds_read_b128 a[148:151], v3 offset:20480
  v_fma_f32 v105, v105, s40, v21
  v_mfma_f32_16x16x32_bf16 v[96:99], a[168:171], a[40:43], v[96:99]
  v_exp_f32 v104, v104
  v_mfma_f32_16x16x32_bf16 v[96:99], a[172:175], a[44:47], v[96:99]
  v_exp_f32 v105, v105
  v_mfma_f32_16x16x32_bf16 v[100:103], a[188:191], a[44:47], 0
  ds_read_b64_tr_b16 a[192:193], v6 offset:16384
  v_fma_f32 v106, v106, s40, v21
  v_mfma_f32_16x16x32_bf16 v[100:103], a[184:187], a[40:43], v[100:103]
  ds_read_b64_tr_b16 a[194:195], v6 offset:20480
  v_fma_f32 v107, v107, s40, v21
  v_mfma_f32_16x16x32_bf16 v[100:103], a[180:183], a[36:39], v[100:103]
  v_exp_f32 v106, v106
  v_mfma_f32_16x16x32_bf16 v[100:103], a[176:179], a[32:35], v[100:103]
  s_add_u32 s45, s45, 8192
  v_mfma_f32_16x16x32_bf16 v[128:131], a[224:227], v[112:115], v[128:131]
  v_exp_f32 v107, v107
  v_mfma_f32_16x16x32_bf16 v[132:135], a[228:231], v[112:115], v[132:135]
  s_add_u32 m0, s44, 57344
  v_cvt_pk_bf16_f32 v116, v104, v105
  v_mfma_f32_16x16x32_bf16 v[136:139], a[232:235], v[112:115], v[136:139]
  buffer_load_dwordx4 v14, s[20:23], s45 offen offset:0 lds
  buffer_load_dwordx4 v15, s[20:23], s45 offen offset:1024 lds
  buffer_load_dwordx4 v16, s[20:23], s45 offen offset:2048 lds
  buffer_load_dwordx4 v17, s[20:23], s45 offen offset:3072 lds
  ds_read_b128 a[136:139], v4 offset:16384
  ds_read_b64_tr_b16 a[196:197], v7 offset:16384
  v_mfma_f32_16x16x32_bf16 v[140:143], a[236:239], v[112:115], v[140:143]
  ds_read_b64_tr_b16 a[198:199], v7 offset:20480
  v_fma_f32 v108, v108, s40, v21
  v_mfma_f32_16x16x32_bf16 v[144:147], a[240:243], v[112:115], v[144:147]
  v_exp_f32 v108, v108
  v_mfma_f32_16x16x32_bf16 v[148:151], a[244:247], v[112:115], v[148:151]
  v_cvt_pk_bf16_f32 v117, v106, v107
  v_fma_f32 v109, v109, s40, v21
  v_mfma_f32_16x16x32_bf16 v[152:155], a[248:251], v[112:115], v[152:155]
  v_exp_f32 v109, v109
  v_mfma_f32_16x16x32_bf16 v[156:159], a[252:255], v[112:115], v[156:159]
  ds_read_b128 a[152:155], v4 offset:20480
  ds_read_b64_tr_b16 a[200:201], v8 offset:16384
  v_fma_f32 v110, v110, s40, v21
  v_fma_f32 v111, v111, s40, v21
  v_exp_f32 v110, v110
  v_exp_f32 v111, v111
  v_mfma_f32_16x16x32_bf16 v[64:67], v[32:35], v[112:115], v[64:67]
  v_cvt_pk_bf16_f32 v118, v108, v109
  v_cvt_pk_bf16_f32 v119, v110, v111
  v_mfma_f32_16x16x32_bf16 v[104:107], a[160:163], a[48:51], 0
  ds_read_b64_tr_b16 a[202:203], v8 offset:20480
  v_fma_f32 v96, v96, s40, v22
  v_mfma_f32_16x16x32_bf16 v[104:107], a[164:167], a[52:55], v[104:107]
  ds_read_b128 a[140:143], v5 offset:16384
  v_fma_f32 v97, v97, s40, v22
  v_mfma_f32_16x16x32_bf16 v[104:107], a[168:171], a[56:59], v[104:107]
  ds_read_b64_tr_b16 a[204:205], v9 offset:16384
  ds_read_b64_tr_b16 a[206:207], v9 offset:20480
  v_mfma_f32_16x16x32_bf16 v[104:107], a[172:175], a[60:63], v[104:107]
  v_exp_f32 v96, v96
  v_mfma_f32_16x16x32_bf16 v[108:111], a[188:191], a[60:63], 0
  v_exp_f32 v97, v97
  v_mfma_f32_16x16x32_bf16 v[108:111], a[184:187], a[56:59], v[108:111]
  v_fma_f32 v98, v98, s40, v22
  v_fma_f32 v99, v99, s40, v22
  v_mfma_f32_16x16x32_bf16 v[108:111], a[180:183], a[52:55], v[108:111]
  v_exp_f32 v98, v98
  v_mfma_f32_16x16x32_bf16 v[108:111], a[176:179], a[48:51], v[108:111]
  v_exp_f32 v99, v99
  v_mfma_f32_16x16x32_bf16 v[160:163], a[224:227], v[116:119], v[160:163]
  ds_read_b128 a[156:159], v5 offset:20480
  ds_read_b64_tr_b16 a[208:209], v10 offset:16384
  v_mfma_f32_16x16x32_bf16 v[164:167], a[228:231], v[116:119], v[164:167]
  s_add_u32 s45, s45, 8192
  s_add_u32 m0, s44, 0
  v_mfma_f32_16x16x32_bf16 v[168:171], a[232:235], v[116:119], v[168:171]
  buffer_load_dwordx4 v14, s[20:23], s45 offen offset:0 lds
  buffer_load_dwordx4 v15, s[20:23], s45 offen offset:1024 lds
  buffer_load_dwordx4 v16, s[20:23], s45 offen offset:2048 lds
  buffer_load_dwordx4 v17, s[20:23], s45 offen offset:3072 lds
  ds_read_b64_tr_b16 a[210:211], v10 offset:20480
  v_mfma_f32_16x16x32_bf16 v[172:175], a[236:239], v[116:119], v[172:175]
  v_cvt_pk_bf16_f32 v112, v96, v97
  v_fma_f32 v100, v100, s40, v22
  v_mfma_f32_16x16x32_bf16 v[176:179], a[240:243], v[116:119], v[176:179]
  v_exp_f32 v100, v100
  v_mfma_f32_16x16x32_bf16 v[180:183], a[244:247], v[116:119], v[180:183]
  ds_read_b64_tr_b16 a[212:213], v11 offset:16384
  v_cvt_pk_bf16_f32 v113, v98, v99
  v_mfma_f32_16x16x32_bf16 v[184:187], a[248:251], v[116:119], v[184:187]
  ds_read_b64_tr_b16 a[214:215], v11 offset:20480
  v_fma_f32 v101, v101, s40, v22
  v_mfma_f32_16x16x32_bf16 v[188:191], a[252:255], v[116:119], v[188:191]
  v_exp_f32 v101, v101
  v_fma_f32 v102, v102, s40, v22
  v_fma_f32 v103, v103, s40, v22
  v_exp_f32 v102, v102
  v_exp_f32 v103, v103
  v_mfma_f32_16x16x32_bf16 v[68:71], v[32:35], v[116:119], v[68:71]
  v_cvt_pk_bf16_f32 v114, v100, v101
  v_cvt_pk_bf16_f32 v115, v102, v103
  s_waitcnt lgkmcnt(4)
  v_mfma_f32_16x16x32_bf16 v[96:99], a[128:131], a[0:3], 0
  ds_read_b64_tr_b16 a[216:217], v12 offset:16384
  v_fma_f32 v104, v104, s40, v23
  v_mfma_f32_16x16x32_bf16 v[96:99], a[132:135], a[4:7], v[96:99]
  ds_read_b64_tr_b16 a[218:219], v12 offset:20480
  v_fma_f32 v105, v105, s40, v23
  v_mfma_f32_16x16x32_bf16 v[96:99], a[136:139], a[8:11], v[96:99]
  v_exp_f32 v104, v104
  v_mfma_f32_16x16x32_bf16 v[96:99], a[140:143], a[12:15], v[96:99]
  v_exp_f32 v105, v105
  v_mfma_f32_16x16x32_bf16 v[100:103], a[156:159], a[12:15], 0
  v_fma_f32 v106, v106, s40, v23
  v_fma_f32 v107, v107, s40, v23
  v_mfma_f32_16x16x32_bf16 v[100:103], a[152:155], a[8:11], v[100:103]
  ds_read_b64_tr_b16 a[220:221], v13 offset:16384
  ds_read_b64_tr_b16 a[222:223], v13 offset:20480
  v_mfma_f32_16x16x32_bf16 v[100:103], a[148:151], a[4:7], v[100:103]
  v_exp_f32 v106, v106
  v_mfma_f32_16x16x32_bf16 v[100:103], a[144:147], a[0:3], v[100:103]
  v_exp_f32 v107, v107
  v_mfma_f32_16x16x32_bf16 v[192:195], a[224:227], v[112:115], v[192:195]
  v_cvt_pk_bf16_f32 v116, v104, v105
  v_fma_f32 v108, v108, s40, v23
  v_mfma_f32_16x16x32_bf16 v[196:199], a[228:231], v[112:115], v[196:199]
  v_exp_f32 v108, v108
  v_mfma_f32_16x16x32_bf16 v[200:203], a[232:235], v[112:115], v[200:203]
  v_cvt_pk_bf16_f32 v117, v106, v107
  v_fma_f32 v109, v109, s40, v23
  v_mfma_f32_16x16x32_bf16 v[204:207], a[236:239], v[112:115], v[204:207]
  v_exp_f32 v109, v109
  v_mfma_f32_16x16x32_bf16 v[208:211], a[240:243], v[112:115], v[208:211]
  v_fma_f32 v110, v110, s40, v23
  v_fma_f32 v111, v111, s40, v23
  v_mfma_f32_16x16x32_bf16 v[212:215], a[244:247], v[112:115], v[212:215]
  v_exp_f32 v110, v110
  v_mfma_f32_16x16x32_bf16 v[216:219], a[248:251], v[112:115], v[216:219]
  v_exp_f32 v111, v111
  v_mfma_f32_16x16x32_bf16 v[220:223], a[252:255], v[112:115], v[220:223]
  v_cvt_pk_bf16_f32 v118, v108, v109
  v_cvt_pk_bf16_f32 v119, v110, v111
  v_mfma_f32_16x16x32_bf16 v[72:75], v[32:35], v[112:115], v[72:75]
  s_waitcnt vmcnt(16) lgkmcnt(0)
  s_branch L_entry
.p2align 6
L_loop:
  s_mov_b32 s52, s50
  s_mov_b32 s53, s51
  s_mov_b32 s50, s48
  s_mov_b32 s51, s49
  s_waitcnt lgkmcnt(0)
  s_barrier
  v_mfma_f32_16x16x32_bf16 v[104:107], a[128:131], a[16:19], 0
  s_add_u32 s45, s45, 8192
  s_add_u32 m0, s44, 57344
  ds_write_b64 v56, v[160:161] offset:0
  s_add_u32 s46, s46, 32
  s_mul_i32 s65, s46, 43691
  s_lshr_b32 s65, s65, 17
  s_lshl_b32 s66, s47, 6
  v_mfma_f32_16x16x32_bf16 v[104:107], a[132:135], a[20:23], v[104:107]
  buffer_load_dwordx4 v14, s[20:23], s45 offen offset:0 lds
  buffer_load_dwordx4 v15, s[20:23], s45 offen offset:1024 lds
  buffer_load_dwordx4 v16, s[20:23], s45 offen offset:2048 lds
  buffer_load_dwordx4 v17, s[20:23], s45 offen offset:3072 lds
  v_mfma_f32_16x16x32_bf16 v[104:107], a[136:139], a[24:27], v[104:107]
  ds_write_b64 v56, v[162:163] offset:32
  s_add_u32 s65, s65, s66
  s_lshl_b32 s49, s65, 17
  s_mul_i32 s66, s47, 192
  s_add_u32 s66, s66, s46
  s_lshl_b32 s48, s66, 16
  s_cmp_lt_u32 s46, 192
  s_cselect_b32 s49, s49, 1073741824
  s_cselect_b32 s48, s48, 1073741824
  v_mfma_f32_16x16x32_bf16 v[104:107], a[140:143], a[28:31], v[104:107]
  ds_write_b64 v56, v[164:165] offset:64
  v_mfma_f32_16x16x32_bf16 v[108:111], a[156:159], a[28:31], 0
  ds_read_b128 a[160:163], v2 offset:8192
  ds_write_b64 v56, v[166:167] offset:96
  s_add_u32 s90, s52, 8192
  v_rcp_f32 v28, v72
  v_cmp_ngt_f32 s[58:59], s42, v72
  v_pk_mul_f32 v[192:193], v[192:193], v[28:29] op_sel_hi:[1,0]
  v_pk_mul_f32 v[194:195], v[194:195], v[28:29] op_sel_hi:[1,0]
  v_pk_mul_f32 v[196:197], v[196:197], v[28:29] op_sel_hi:[1,0]
  v_pk_mul_f32 v[198:199], v[198:199], v[28:29] op_sel_hi:[1,0]
  v_pk_mul_f32 v[200:201], v[200:201], v[28:29] op_sel_hi:[1,0]
  v_pk_mul_f32 v[202:203], v[202:203], v[28:29] op_sel_hi:[1,0]
  v_pk_mul_f32 v[204:205], v[204:205], v[28:29] op_sel_hi:[1,0]
  v_pk_mul_f32 v[206:207], v[206:207], v[28:29] op_sel_hi:[1,0]
  v_pk_mul_f32 v[208:209], v[208:209], v[28:29] op_sel_hi:[1,0]
  v_pk_mul_f32 v[210:211], v[210:211], v[28:29] op_sel_hi:[1,0]
  v_pk_mul_f32 v[212:213], v[212:213], v[28:29] op_sel_hi:[1,0]
  v_pk_mul_f32 v[214:215], v[214:215], v[28:29] op_sel_hi:[1,0]
  v_pk_mul_f32 v[216:217], v[216:217], v[28:29] op_sel_hi:[1,0]
  v_pk_mul_f32 v[218:219], v[218:219], v[28:29] op_sel_hi:[1,0]
  v_pk_mul_f32 v[220:221], v[220:221], v[28:29] op_sel_hi:[1,0]
  v_pk_mul_f32 v[222:223], v[222:223], v[28:29] op_sel_hi:[1,0]
  v_mfma_f32_16x16x32_bf16 v[108:111], a[152:155], a[24:27], v[108:111]
  ds_write_b64 v56, v[168:169] offset:128
  v_cvt_pk_bf16_f32 v192, v192, v193
  v_cvt_pk_bf16_f32 v193, v194, v195
  v_cvt_pk_bf16_f32 v194, v196, v197
  v_cvt_pk_bf16_f32 v195, v198, v199
  v_cvt_pk_bf16_f32 v196, v200, v201
  v_cvt_pk_bf16_f32 v197, v202, v203
  v_mfma_f32_16x16x32_bf16 v[108:111], a[148:151], a[20:23], v[108:111]
  ds_write_b64 v56, v[170:171] offset:160
  v_cvt_pk_bf16_f32 v198, v204, v205
  v_cvt_pk_bf16_f32 v199, v206, v207
  v_cvt_pk_bf16_f32 v200, v208, v209
  v_cvt_pk_bf16_f32 v201, v210, v211
  v_cvt_pk_bf16_f32 v202, v212, v213
  v_cvt_pk_bf16_f32 v203, v214, v215
  v_mfma_f32_16x16x32_bf16 v[108:111], a[144:147], a[16:19], v[108:111]
  ds_write_b64 v56, v[172:173] offset:192
  v_max3_f32 v60, v96, v97, v98
  v_max3_f32 v61, v99, v100, v101
  v_cvt_pk_bf16_f32 v204, v216, v217
  v_cvt_pk_bf16_f32 v205, v218, v219
  v_cvt_pk_bf16_f32 v206, v220, v221
  v_cvt_pk_bf16_f32 v207, v222, v223
  v_mfma_f32_16x16x32_bf16 v[224:227], a[224:227], v[116:119], v[224:227]
  ds_write_b64 v56, v[174:175] offset:224
  ds_read_b128 v[120:123], v57 offset:0
  ds_read_b128 v[124:127], v57 offset:1088
  ds_read_b128 v[36:39], v57 offset:2176
  ds_read_b128 v[40:43], v57 offset:3264
  v_max3_f32 v60, v102, v103, v60
  v_max_f32 v60, v60, v61
  v_mfma_f32_16x16x32_bf16 v[228:231], a[228:231], v[116:119], v[228:231]
  ds_read_b128 a[176:179], v2 offset:12288
  v_mov_b32 v61, v60
  v_mfma_f32_16x16x32_bf16 v[232:235], a[232:235], v[116:119], v[232:235]
  s_nop 0
  v_permlane32_swap_b32 v61, v60
  v_mfma_f32_16x16x32_bf16 v[236:239], a[236:239], v[116:119], v[236:239]
  v_max_f32 v60, v60, v61
  v_mov_b32 v61, v60
  v_mfma_f32_16x16x32_bf16 v[240:243], a[240:243], v[116:119], v[240:243]
  s_nop 0
  v_permlane16_swap_b32 v61, v60
  v_mfma_f32_16x16x32_bf16 v[244:247], a[244:247], v[116:119], v[244:247]
  v_max_f32 v60, v60, v61
  v_mul_f32 v20, s41, v60
  v_fma_f32 v96, v96, s40, v20
  v_fma_f32 v97, v97, s40, v20
  v_exp_f32 v96, v96
  v_exp_f32 v97, v97
  v_fma_f32 v98, v98, s40, v20
  v_fma_f32 v99, v99, s40, v20
  v_exp_f32 v98, v98
  v_exp_f32 v99, v99
  v_mfma_f32_16x16x32_bf16 v[248:251], a[248:251], v[116:119], v[248:251]
  v_cvt_pk_bf16_f32 v112, v96, v97
  v_fma_f32 v100, v100, s40, v20
  v_exp_f32 v100, v100
  v_mfma_f32_16x16x32_bf16 v[252:255], a[252:255], v[116:119], v[252:255]
  v_cvt_pk_bf16_f32 v113, v98, v99
  v_fma_f32 v101, v101, s40, v20
  v_exp_f32 v101, v101
  v_fma_f32 v102, v102, s40, v20
  v_fma_f32 v103, v103, s40, v20
  v_exp_f32 v102, v102
  v_exp_f32 v103, v103
  v_mfma_f32_16x16x32_bf16 v[76:79], v[32:35], v[116:119], v[76:79]
  v_cvt_pk_bf16_f32 v114, v100, v101
  v_cvt_pk_bf16_f32 v115, v102, v103
  v_mfma_f32_16x16x32_bf16 v[96:99], a[128:131], a[32:35], 0
  ds_read_b128 a[164:167], v3 offset:8192
  ds_read_b128 a[180:183], v3 offset:12288
  v_mfma_f32_16x16x32_bf16 v[96:99], a[132:135], a[36:39], v[96:99]
  ds_read_b64_tr_b16 a[224:225], v6 offset:8192
  buffer_store_dwordx4 v[80:83], v19, s[24:27], s88 offen offset:0 sc0 sc1
  buffer_store_dwordx4 v[84:87], v19, s[24:27], s88 offen offset:1024 sc0 sc1
  v_mfma_f32_16x16x32_bf16 v[96:99], a[136:139], a[40:43], v[96:99]
  ds_read_b64_tr_b16 a[226:227], v6 offset:12288
  v_max3_f32 v62, v104, v105, v106
  v_mfma_f32_16x16x32_bf16 v[96:99], a[140:143], a[44:47], v[96:99]
  ds_read_b128 a[168:171], v4 offset:8192
  v_max3_f32 v63, v107, v108, v109
  v_mfma_f32_16x16x32_bf16 v[100:103], a[156:159], a[44:47], 0
  ds_read_b64_tr_b16 a[228:229], v7 offset:8192
  v_max3_f32 v62, v110, v111, v62
  v_mfma_f32_16x16x32_bf16 v[100:103], a[152:155], a[40:43], v[100:103]
  v_max_f32 v62, v62, v63
  v_mov_b32 v63, v62
  v_mfma_f32_16x16x32_bf16 v[100:103], a[148:151], a[36:39], v[100:103]
  ds_read_b64_tr_b16 a[230:231], v7 offset:12288
  v_permlane32_swap_b32 v63, v62
  v_mfma_f32_16x16x32_bf16 v[100:103], a[144:147], a[32:35], v[100:103]
  v_max_f32 v62, v62, v63
  v_mov_b32 v63, v62
  v_mfma_f32_16x16x32_bf16 v[128:131], a[192:195], v[112:115], 0
  s_nop 0
  v_permlane16_swap_b32 v63, v62
  v_mfma_f32_16x16x32_bf16 v[132:135], a[196:199], v[112:115], 0
  ds_write_b64 v56, v[192:193] offset:0
  s_add_u32 s91, s52, 12288
  v_max_f32 v62, v62, v63
  v_mul_f32 v21, s41, v62
  v_rcp_f32 v30, v76
  v_cmp_ngt_f32 s[60:61], s42, v76
  v_mfma_f32_16x16x32_bf16 v[136:139], a[200:203], v[112:115], 0
  ds_write_b64 v56, v[194:195] offset:32
  v_fma_f32 v104, v104, s40, v21
  v_fma_f32 v105, v105, s40, v21
  v_pk_mul_f32 v[224:225], v[224:225], v[30:31] op_sel_hi:[1,0]
  v_pk_mul_f32 v[226:227], v[226:227], v[30:31] op_sel_hi:[1,0]
  v_pk_mul_f32 v[228:229], v[228:229], v[30:31] op_sel_hi:[1,0]
  v_pk_mul_f32 v[230:231], v[230:231], v[30:31] op_sel_hi:[1,0]
  v_pk_mul_f32 v[232:233], v[232:233], v[30:31] op_sel_hi:[1,0]
  v_pk_mul_f32 v[234:235], v[234:235], v[30:31] op_sel_hi:[1,0]
  v_pk_mul_f32 v[236:237], v[236:237], v[30:31] op_sel_hi:[1,0]
  v_pk_mul_f32 v[238:239], v[238:239], v[30:31] op_sel_hi:[1,0]
  v_pk_mul_f32 v[240:241], v[240:241], v[30:31] op_sel_hi:[1,0]
  v_pk_mul_f32 v[242:243], v[242:243], v[30:31] op_sel_hi:[1,0]
  v_pk_mul_f32 v[244:245], v[244:245], v[30:31] op_sel_hi:[1,0]
  v_pk_mul_f32 v[246:247], v[246:247], v[30:31] op_sel_hi:[1,0]
  v_pk_mul_f32 v[248:249], v[248:249], v[30:31] op_sel_hi:[1,0]
  v_pk_mul_f32 v[250:251], v[250:251], v[30:31] op_sel_hi:[1,0]
  v_pk_mul_f32 v[252:253], v[252:253], v[30:31] op_sel_hi:[1,0]
  v_pk_mul_f32 v[254:255], v[254:255], v[30:31] op_sel_hi:[1,0]
  v_mfma_f32_16x16x32_bf16 v[140:143], a[204:207], v[112:115], 0
  ds_write_b64 v56, v[196:197] offset:64
  v_exp_f32 v104, v104
  v_cvt_pk_bf16_f32 v224, v224, v225
  v_cvt_pk_bf16_f32 v225, v226, v227
  v_cvt_pk_bf16_f32 v226, v228, v229
  v_cvt_pk_bf16_f32 v227, v230, v231
  v_mfma_f32_16x16x32_bf16 v[144:147], a[208:211], v[112:115], 0
  ds_write_b64 v56, v[198:199] offset:96
  v_exp_f32 v105, v105
  v_cvt_pk_bf16_f32 v228, v232, v233
  v_cvt_pk_bf16_f32 v229, v234, v235
  v_cvt_pk_bf16_f32 v230, v236, v237
  v_cvt_pk_bf16_f32 v231, v238, v239
  v_mfma_f32_16x16x32_bf16 v[148:151], a[212:215], v[112:115], 0
  ds_write_b64 v56, v[200:201] offset:128
  v_fma_f32 v106, v106, s40, v21
  v_fma_f32 v107, v107, s40, v21
  v_exp_f32 v106, v106
  v_exp_f32 v107, v107
  v_mfma_f32_16x16x32_bf16 v[152:155], a[216:219], v[112:115], 0
  ds_write_b64 v56, v[202:203] offset:160
  v_cvt_pk_bf16_f32 v116, v104, v105
  v_fma_f32 v108, v108, s40, v21
  v_exp_f32 v108, v108
  v_cvt_pk_bf16_f32 v232, v240, v241
  v_cvt_pk_bf16_f32 v233, v242, v243
  v_mfma_f32_16x16x32_bf16 v[156:159], a[220:223], v[112:115], 0
  ds_read_b128 a[184:187], v4 offset:12288
  ds_read_b64_tr_b16 a[232:233], v8 offset:8192
  v_cvt_pk_bf16_f32 v117, v106, v107
  v_fma_f32 v109, v109, s40, v21
  v_exp_f32 v109, v109
  v_fma_f32 v110, v110, s40, v21
  v_fma_f32 v111, v111, s40, v21
  v_exp_f32 v110, v110
  v_exp_f32 v111, v111
  v_mfma_f32_16x16x32_bf16 v[64:67], v[32:35], v[112:115], 0
  ds_write_b64 v56, v[204:205] offset:192
  v_cvt_pk_bf16_f32 v118, v108, v109
  v_cvt_pk_bf16_f32 v119, v110, v111
  v_cvt_pk_bf16_f32 v234, v244, v245
  v_cvt_pk_bf16_f32 v235, v246, v247
  v_cvt_pk_bf16_f32 v236, v248, v249
  v_cvt_pk_bf16_f32 v237, v250, v251
  v_mfma_f32_16x16x32_bf16 v[104:107], a[128:131], a[48:51], 0
  ds_read_b64_tr_b16 a[234:235], v8 offset:12288
  ds_read_b128 a[172:175], v5 offset:8192
  ds_write_b64 v56, v[206:207] offset:224
  ds_read_b128 a[96:99], v57 offset:0
  ds_read_b128 a[100:103], v57 offset:1088
  ds_read_b128 a[104:107], v57 offset:2176
  ds_read_b128 a[108:111], v57 offset:3264
  v_mfma_f32_16x16x32_bf16 v[104:107], a[132:135], a[52:55], v[104:107]
  ds_read_b64_tr_b16 a[236:237], v9 offset:8192
  ds_read_b64_tr_b16 a[238:239], v9 offset:12288
  v_cvt_pk_bf16_f32 v238, v252, v253
  v_cvt_pk_bf16_f32 v239, v254, v255
  v_mfma_f32_16x16x32_bf16 v[104:107], a[136:139], a[56:59], v[104:107]
  ds_read_b128 a[188:191], v5 offset:12288
  ds_read_b64_tr_b16 a[240:241], v10 offset:8192
  v_mfma_f32_16x16x32_bf16 v[104:107], a[140:143], a[60:63], v[104:107]
  v_max3_f32 v60, v96, v97, v98
  v_max3_f32 v61, v99, v100, v101
  v_mfma_f32_16x16x32_bf16 v[108:111], a[156:159], a[60:63], 0
  ds_read_b64_tr_b16 a[242:243], v10 offset:12288
  v_max3_f32 v60, v102, v103, v60
  v_mfma_f32_16x16x32_bf16 v[108:111], a[152:155], a[56:59], v[108:111]
  v_max_f32 v60, v60, v61
  v_mov_b32 v61, v60
  v_mfma_f32_16x16x32_bf16 v[108:111], a[148:151], a[52:55], v[108:111]
  s_nop 0
  v_permlane32_swap_b32 v61, v60
  v_mfma_f32_16x16x32_bf16 v[108:111], a[144:147], a[48:51], v[108:111]
  v_max_f32 v60, v60, v61
  v_mov_b32 v61, v60
  v_mfma_f32_16x16x32_bf16 v[160:163], a[192:195], v[116:119], 0
  s_nop 0
  v_permlane16_swap_b32 v61, v60
  v_mfma_f32_16x16x32_bf16 v[164:167], a[196:199], v[116:119], 0
  v_max_f32 v60, v60, v61
  v_mul_f32 v22, s41, v60
  v_mfma_f32_16x16x32_bf16 v[168:171], a[200:203], v[116:119], 0
  ds_read_b64_tr_b16 a[244:245], v11 offset:8192
  v_fma_f32 v96, v96, s40, v22
  v_mfma_f32_16x16x32_bf16 v[172:175], a[204:207], v[116:119], 0
  v_fma_f32 v97, v97, s40, v22
  v_exp_f32 v96, v96
  v_mfma_f32_16x16x32_bf16 v[176:179], a[208:211], v[116:119], 0
  v_exp_f32 v97, v97
  v_mfma_f32_16x16x32_bf16 v[180:183], a[212:215], v[116:119], 0
  v_fma_f32 v98, v98, s40, v22
  v_fma_f32 v99, v99, s40, v22
  v_exp_f32 v98, v98
  v_exp_f32 v99, v99
  v_mfma_f32_16x16x32_bf16 v[184:187], a[216:219], v[116:119], 0
  v_cvt_pk_bf16_f32 v112, v96, v97
  v_fma_f32 v100, v100, s40, v22
  v_exp_f32 v100, v100
  v_mfma_f32_16x16x32_bf16 v[188:191], a[220:223], v[116:119], 0
  ds_read_b64_tr_b16 a[246:247], v11 offset:12288
  v_cvt_pk_bf16_f32 v113, v98, v99
  v_fma_f32 v101, v101, s40, v22
  v_exp_f32 v101, v101
  v_fma_f32 v102, v102, s40, v22
  v_fma_f32 v103, v103, s40, v22
  v_exp_f32 v102, v102
  v_exp_f32 v103, v103
  v_mfma_f32_16x16x32_bf16 v[68:71], v[32:35], v[116:119], 0
  ds_write_b64 v56, v[224:225] offset:0
  v_cvt_pk_bf16_f32 v114, v100, v101
  v_cvt_pk_bf16_f32 v115, v102, v103
  s_waitcnt lgkmcnt(5)
  v_mfma_f32_16x16x32_bf16 v[96:99], a[160:163], a[0:3], 0
  ds_read_b64_tr_b16 a[248:249], v12 offset:8192
  ds_write_b64 v56, v[226:227] offset:32
  v_mfma_f32_16x16x32_bf16 v[96:99], a[164:167], a[4:7], v[96:99]
  ds_read_b64_tr_b16 a[250:251], v12 offset:12288
  ds_write_b64 v56, v[228:229] offset:64
  v_mfma_f32_16x16x32_bf16 v[96:99], a[168:171], a[8:11], v[96:99]
  ds_write_b64 v56, v[230:231] offset:96
  v_mfma_f32_16x16x32_bf16 v[96:99], a[172:175], a[12:15], v[96:99]
  ds_read_b64_tr_b16 a[252:253], v13 offset:8192
  ds_write_b64 v56, v[232:233] offset:128
  v_mfma_f32_16x16x32_bf16 v[100:103], a[188:191], a[12:15], 0
  ds_write_b64 v56, v[234:235] offset:160
  v_mfma_f32_16x16x32_bf16 v[100:103], a[184:187], a[8:11], v[100:103]
  ds_read_b64_tr_b16 a[254:255], v13 offset:12288
  ds_write_b64 v56, v[236:237] offset:192
  v_mfma_f32_16x16x32_bf16 v[100:103], a[180:183], a[4:7], v[100:103]
  ds_write_b64 v56, v[238:239] offset:224
  ds_read_b128 a[112:115], v57 offset:0
  ds_read_b128 a[116:119], v57 offset:1088
  ds_read_b128 a[120:123], v57 offset:2176
  ds_read_b128 a[124:127], v57 offset:3264
  s_or_b64 s[54:55], s[54:55], s[56:57]
  s_or_b64 s[58:59], s[58:59], s[60:61]
  v_mfma_f32_16x16x32_bf16 v[100:103], a[176:179], a[0:3], v[100:103]
  s_or_b64 s[54:55], s[54:55], s[58:59]
  s_cbranch_scc1 L_slow0
L_ret0:
  v_max3_f32 v62, v104, v105, v106
  v_max3_f32 v63, v107, v108, v109
  v_mfma_f32_16x16x32_bf16 v[192:195], a[192:195], v[112:115], 0
  v_max3_f32 v62, v110, v111, v62
  v_max_f32 v62, v62, v63
  v_mfma_f32_16x16x32_bf16 v[196:199], a[196:199], v[112:115], 0
  v_mov_b32 v63, v62
  v_mfma_f32_16x16x32_bf16 v[200:203], a[200:203], v[112:115], 0
  s_nop 0
  v_permlane32_swap_b32 v63, v62
  v_mfma_f32_16x16x32_bf16 v[204:207], a[204:207], v[112:115], 0
  v_max_f32 v62, v62, v63
  v_mov_b32 v63, v62
  v_mfma_f32_16x16x32_bf16 v[208:211], a[208:211], v[112:115], 0
  s_nop 0
  v_permlane16_swap_b32 v63, v62
  v_mfma_f32_16x16x32_bf16 v[212:215], a[212:215], v[112:115], 0
  v_max_f32 v62, v62, v63
  v_mul_f32 v23, s41, v62
  v_fma_f32 v104, v104, s40, v23
  v_fma_f32 v105, v105, s40, v23
  v_exp_f32 v104, v104
  v_exp_f32 v105, v105
  v_fma_f32 v106, v106, s40, v23
  v_fma_f32 v107, v107, s40, v23
  v_exp_f32 v106, v106
  v_exp_f32 v107, v107
  v_mfma_f32_16x16x32_bf16 v[216:219], a[216:219], v[112:115], 0
  v_cvt_pk_bf16_f32 v116, v104, v105
  v_fma_f32 v108, v108, s40, v23
  v_exp_f32 v108, v108
  v_mfma_f32_16x16x32_bf16 v[220:223], a[220:223], v[112:115], 0
  v_cvt_pk_bf16_f32 v117, v106, v107
  v_fma_f32 v109, v109, s40, v23
  v_exp_f32 v109, v109
  v_fma_f32 v110, v110, s40, v23
  v_fma_f32 v111, v111, s40, v23
  v_exp_f32 v110, v110
  v_exp_f32 v111, v111
  v_mfma_f32_16x16x32_bf16 v[72:75], v[32:35], v[112:115], 0
  v_cvt_pk_bf16_f32 v118, v108, v109
  v_cvt_pk_bf16_f32 v119, v110, v111
  v_mfma_f32_16x16x32_bf16 v[104:107], a[160:163], a[16:19], 0
  v_fma_f32 v96, v96, s40, v20
  v_fma_f32 v97, v97, s40, v20
  v_mfma_f32_16x16x32_bf16 v[104:107], a[164:167], a[20:23], v[104:107]
  v_exp_f32 v96, v96
  v_mfma_f32_16x16x32_bf16 v[104:107], a[168:171], a[24:27], v[104:107]
  v_exp_f32 v97, v97
  v_mfma_f32_16x16x32_bf16 v[104:107], a[172:175], a[28:31], v[104:107]
  v_fma_f32 v98, v98, s40, v20
  v_fma_f32 v99, v99, s40, v20
  v_mfma_f32_16x16x32_bf16 v[108:111], a[188:191], a[28:31], 0
  v_exp_f32 v98, v98
  v_mfma_f32_16x16x32_bf16 v[108:111], a[184:187], a[24:27], v[108:111]
  ds_read_b128 a[128:131], v2 offset:16384
  ds_read_b128 a[144:147], v2 offset:20480
  v_mfma_f32_16x16x32_bf16 v[108:111], a[180:183], a[20:23], v[108:111]
  v_exp_f32 v99, v99
  v_mfma_f32_16x16x32_bf16 v[108:111], a[176:179], a[16:19], v[108:111]
  v_cvt_pk_bf16_f32 v112, v96, v97
  v_fma_f32 v100, v100, s40, v20
  v_mfma_f32_16x16x32_bf16 v[224:227], a[192:195], v[116:119], 0
  v_exp_f32 v100, v100
  v_mfma_f32_16x16x32_bf16 v[228:231], a[196:199], v[116:119], 0
  v_cvt_pk_bf16_f32 v113, v98, v99
  v_fma_f32 v101, v101, s40, v20
  v_mfma_f32_16x16x32_bf16 v[232:235], a[200:203], v[116:119], 0
  v_exp_f32 v101, v101
  v_mfma_f32_16x16x32_bf16 v[236:239], a[204:207], v[116:119], 0
  v_fma_f32 v102, v102, s40, v20
  v_fma_f32 v103, v103, s40, v20
  v_mfma_f32_16x16x32_bf16 v[240:243], a[208:211], v[116:119], 0
  v_exp_f32 v102, v102
  v_mfma_f32_16x16x32_bf16 v[244:247], a[212:215], v[116:119], 0
  v_exp_f32 v103, v103
  v_mfma_f32_16x16x32_bf16 v[248:251], a[216:219], v[116:119], 0
  v_cvt_pk_bf16_f32 v114, v100, v101
  v_cvt_pk_bf16_f32 v115, v102, v103
  v_mfma_f32_16x16x32_bf16 v[252:255], a[220:223], v[116:119], 0
  ds_read_b128 a[132:135], v3 offset:16384
  v_fma_f32 v104, v104, s40, v21
  v_mfma_f32_16x16x32_bf16 v[76:79], v[32:35], v[116:119], 0
  ds_read_b128 a[148:151], v3 offset:20480
  v_fma_f32 v105, v105, s40, v21
  v_mfma_f32_16x16x32_bf16 v[96:99], a[160:163], a[32:35], 0
  v_exp_f32 v104, v104
  v_mfma_f32_16x16x32_bf16 v[96:99], a[164:167], a[36:39], v[96:99]
  v_exp_f32 v105, v105
  v_mfma_f32_16x16x32_bf16 v[96:99], a[168:171], a[40:43], v[96:99]
  ds_read_b64_tr_b16 a[192:193], v6 offset:16384
  v_fma_f32 v106, v106, s40, v21
  v_mfma_f32_16x16x32_bf16 v[96:99], a[172:175], a[44:47], v[96:99]
  ds_read_b64_tr_b16 a[194:195], v6 offset:20480
  v_fma_f32 v107, v107, s40, v21
  v_mfma_f32_16x16x32_bf16 v[100:103], a[188:191], a[44:47], 0
  v_exp_f32 v106, v106
  v_mfma_f32_16x16x32_bf16 v[100:103], a[184:187], a[40:43], v[100:103]
  v_exp_f32 v107, v107
  v_mfma_f32_16x16x32_bf16 v[100:103], a[180:183], a[36:39], v[100:103]
  buffer_store_dwordx4 v[88:91], v19, s[24:27], s88 offen offset:2048 sc0 sc1
  buffer_store_dwordx4 v[92:95], v19, s[24:27], s88 offen offset:3072 sc0 sc1
  v_mfma_f32_16x16x32_bf16 v[100:103], a[176:179], a[32:35], v[100:103]
  v_cvt_pk_bf16_f32 v116, v104, v105
  s_waitcnt lgkmcnt(12)
  v_mfma_f32_16x16x32_bf16 v[128:131], a[224:227], v[112:115], v[128:131]
  ds_read_b128 a[136:139], v4 offset:16384
  v_fma_f32 v108, v108, s40, v21
  v_mfma_f32_16x16x32_bf16 v[132:135], a[228:231], v[112:115], v[132:135]
  v_exp_f32 v108, v108
  v_mfma_f32_16x16x32_bf16 v[136:139], a[232:235], v[112:115], v[136:139]
  ds_read_b64_tr_b16 a[196:197], v7 offset:16384
  v_cvt_pk_bf16_f32 v117, v106, v107
  v_mfma_f32_16x16x32_bf16 v[140:143], a[236:239], v[112:115], v[140:143]
  ds_read_b64_tr_b16 a[198:199], v7 offset:20480
  v_fma_f32 v109, v109, s40, v21
  v_mfma_f32_16x16x32_bf16 v[144:147], a[240:243], v[112:115], v[144:147]
  v_exp_f32 v109, v109
  v_mfma_f32_16x16x32_bf16 v[148:151], a[244:247], v[112:115], v[148:151]
  v_fma_f32 v110, v110, s40, v21
  v_fma_f32 v111, v111, s40, v21
  v_mfma_f32_16x16x32_bf16 v[152:155], a[248:251], v[112:115], v[152:155]
  v_exp_f32 v110, v110
  v_mfma_f32_16x16x32_bf16 v[156:159], a[252:255], v[112:115], v[156:159]
  ds_read_b128 a[152:155], v4 offset:20480
  ds_read_b64_tr_b16 a[200:201], v8 offset:16384
  v_exp_f32 v111, v111
  v_mfma_f32_16x16x32_bf16 v[64:67], v[32:35], v[112:115], v[64:67]
  v_cvt_pk_bf16_f32 v118, v108, v109
  v_cvt_pk_bf16_f32 v119, v110, v111
  v_mfma_f32_16x16x32_bf16 v[104:107], a[160:163], a[48:51], 0
  ds_read_b64_tr_b16 a[202:203], v8 offset:20480
  v_fma_f32 v96, v96, s40, v22
  v_mfma_f32_16x16x32_bf16 v[104:107], a[164:167], a[52:55], v[104:107]
  ds_read_b128 a[140:143], v5 offset:16384
  v_fma_f32 v97, v97, s40, v22
  v_mfma_f32_16x16x32_bf16 v[104:107], a[168:171], a[56:59], v[104:107]
  ds_read_b64_tr_b16 a[204:205], v9 offset:16384
  ds_read_b64_tr_b16 a[206:207], v9 offset:20480
  v_mfma_f32_16x16x32_bf16 v[104:107], a[172:175], a[60:63], v[104:107]
  v_exp_f32 v96, v96
  v_mfma_f32_16x16x32_bf16 v[108:111], a[188:191], a[60:63], 0
  v_exp_f32 v97, v97
  v_mfma_f32_16x16x32_bf16 v[108:111], a[184:187], a[56:59], v[108:111]
  v_fma_f32 v98, v98, s40, v22
  v_fma_f32 v99, v99, s40, v22
  v_mfma_f32_16x16x32_bf16 v[108:111], a[180:183], a[52:55], v[108:111]
  v_exp_f32 v98, v98
  v_mfma_f32_16x16x32_bf16 v[108:111], a[176:179], a[48:51], v[108:111]
  v_exp_f32 v99, v99
  v_mfma_f32_16x16x32_bf16 v[160:163], a[224:227], v[116:119], v[160:163]
  ds_read_b128 a[156:159], v5 offset:20480
  ds_read_b64_tr_b16 a[208:209], v10 offset:16384
  v_mfma_f32_16x16x32_bf16 v[164:167], a[228:231], v[116:119], v[164:167]
  v_cvt_pk_bf16_f32 v112, v96, v97
  v_fma_f32 v100, v100, s40, v22
  v_mfma_f32_16x16x32_bf16 v[168:171], a[232:235], v[116:119], v[168:171]
  ds_read_b64_tr_b16 a[210:211], v10 offset:20480
  ds_read_b64_tr_b16 a[212:213], v11 offset:16384
  v_mfma_f32_16x16x32_bf16 v[172:175], a[236:239], v[116:119], v[172:175]
  v_exp_f32 v100, v100
  v_mfma_f32_16x16x32_bf16 v[176:179], a[240:243], v[116:119], v[176:179]
  v_cvt_pk_bf16_f32 v113, v98, v99
  v_fma_f32 v101, v101, s40, v22
  v_mfma_f32_16x16x32_bf16 v[180:183], a[244:247], v[116:119], v[180:183]
  v_exp_f32 v101, v101
  v_mfma_f32_16x16x32_bf16 v[184:187], a[248:251], v[116:119], v[184:187]
  v_fma_f32 v102, v102, s40, v22
  v_fma_f32 v103, v103, s40, v22
  v_mfma_f32_16x16x32_bf16 v[188:191], a[252:255], v[116:119], v[188:191]
  ds_read_b64_tr_b16 a[214:215], v11 offset:20480
  v_exp_f32 v102, v102
  v_exp_f32 v103, v103
  v_mfma_f32_16x16x32_bf16 v[68:71], v[32:35], v[116:119], v[68:71]
  v_cvt_pk_bf16_f32 v114, v100, v101
  v_cvt_pk_bf16_f32 v115, v102, v103
  s_waitcnt lgkmcnt(4)
  v_mfma_f32_16x16x32_bf16 v[96:99], a[128:131], a[0:3], 0
  ds_read_b64_tr_b16 a[216:217], v12 offset:16384
  v_fma_f32 v104, v104, s40, v23
  v_mfma_f32_16x16x32_bf16 v[96:99], a[132:135], a[4:7], v[96:99]
  ds_read_b64_tr_b16 a[218:219], v12 offset:20480
  v_fma_f32 v105, v105, s40, v23
  v_mfma_f32_16x16x32_bf16 v[96:99], a[136:139], a[8:11], v[96:99]
  v_exp_f32 v104, v104
  v_mfma_f32_16x16x32_bf16 v[96:99], a[140:143], a[12:15], v[96:99]
  v_exp_f32 v105, v105
  v_mfma_f32_16x16x32_bf16 v[100:103], a[156:159], a[12:15], 0
  v_fma_f32 v106, v106, s40, v23
  v_fma_f32 v107, v107, s40, v23
  v_mfma_f32_16x16x32_bf16 v[100:103], a[152:155], a[8:11], v[100:103]
  ds_read_b64_tr_b16 a[220:221], v13 offset:16384
  ds_read_b64_tr_b16 a[222:223], v13 offset:20480
  v_mfma_f32_16x16x32_bf16 v[100:103], a[148:151], a[4:7], v[100:103]
  v_exp_f32 v106, v106
  v_mfma_f32_16x16x32_bf16 v[100:103], a[144:147], a[0:3], v[100:103]
  v_exp_f32 v107, v107
  v_mfma_f32_16x16x32_bf16 v[192:195], a[224:227], v[112:115], v[192:195]
  v_cvt_pk_bf16_f32 v116, v104, v105
  v_fma_f32 v108, v108, s40, v23
  v_mfma_f32_16x16x32_bf16 v[196:199], a[228:231], v[112:115], v[196:199]
  v_exp_f32 v108, v108
  v_mfma_f32_16x16x32_bf16 v[200:203], a[232:235], v[112:115], v[200:203]
  s_add_u32 s45, s45, 8192
  v_cvt_pk_bf16_f32 v117, v106, v107
  v_mfma_f32_16x16x32_bf16 v[204:207], a[236:239], v[112:115], v[204:207]
  s_add_u32 m0, s44, 0
  v_fma_f32 v109, v109, s40, v23
  v_mfma_f32_16x16x32_bf16 v[208:211], a[240:243], v[112:115], v[208:211]
  v_exp_f32 v109, v109
  v_mfma_f32_16x16x32_bf16 v[212:215], a[244:247], v[112:115], v[212:215]
  v_fma_f32 v110, v110, s40, v23
  v_fma_f32 v111, v111, s40, v23
  v_mfma_f32_16x16x32_bf16 v[216:219], a[248:251], v[112:115], v[216:219]
  v_exp_f32 v110, v110
  v_mfma_f32_16x16x32_bf16 v[220:223], a[252:255], v[112:115], v[220:223]
  buffer_load_dwordx4 v14, s[20:23], s45 offen offset:0 lds
  buffer_load_dwordx4 v15, s[20:23], s45 offen offset:1024 lds
  buffer_load_dwordx4 v16, s[20:23], s45 offen offset:2048 lds
  buffer_load_dwordx4 v17, s[20:23], s45 offen offset:3072 lds
  v_exp_f32 v111, v111
  v_mfma_f32_16x16x32_bf16 v[72:75], v[32:35], v[112:115], v[72:75]
  v_cvt_pk_bf16_f32 v118, v108, v109
  v_cvt_pk_bf16_f32 v119, v110, v111
  s_waitcnt vmcnt(26) lgkmcnt(0)
  L_entry:
  s_barrier
  v_mfma_f32_16x16x32_bf16 v[104:107], a[128:131], a[16:19], 0
  v_fma_f32 v96, v96, s40, v20
  v_fma_f32 v97, v97, s40, v20
  v_mfma_f32_16x16x32_bf16 v[104:107], a[132:135], a[20:23], v[104:107]
  v_exp_f32 v96, v96
  v_mfma_f32_16x16x32_bf16 v[104:107], a[136:139], a[24:27], v[104:107]
  v_exp_f32 v97, v97
  v_mfma_f32_16x16x32_bf16 v[104:107], a[140:143], a[28:31], v[104:107]
  v_fma_f32 v98, v98, s40, v20
  v_fma_f32 v99, v99, s40, v20
  v_mfma_f32_16x16x32_bf16 v[108:111], a[156:159], a[28:31], 0
  v_exp_f32 v98, v98
  v_mfma_f32_16x16x32_bf16 v[108:111], a[152:155], a[24:27], v[108:111]
  ds_read_b128 a[160:163], v2 offset:24576
  ds_read_b128 a[176:179], v2 offset:28672
  v_mfma_f32_16x16x32_bf16 v[108:111], a[148:151], a[20:23], v[108:111]
  v_exp_f32 v99, v99
  v_mfma_f32_16x16x32_bf16 v[108:111], a[144:147], a[16:19], v[108:111]
  v_cvt_pk_bf16_f32 v112, v96, v97
  v_fma_f32 v100, v100, s40, v20
  v_mfma_f32_16x16x32_bf16 v[224:227], a[224:227], v[116:119], v[224:227]
  v_exp_f32 v100, v100
  v_mfma_f32_16x16x32_bf16 v[228:231], a[228:231], v[116:119], v[228:231]
  v_cvt_pk_bf16_f32 v113, v98, v99
  v_fma_f32 v101, v101, s40, v20
  v_mfma_f32_16x16x32_bf16 v[232:235], a[232:235], v[116:119], v[232:235]
  v_exp_f32 v101, v101
  v_mfma_f32_16x16x32_bf16 v[236:239], a[236:239], v[116:119], v[236:239]
  v_fma_f32 v102, v102, s40, v20
  v_fma_f32 v103, v103, s40, v20
  v_mfma_f32_16x16x32_bf16 v[240:243], a[240:243], v[116:119], v[240:243]
  v_exp_f32 v102, v102
  v_mfma_f32_16x16x32_bf16 v[244:247], a[244:247], v[116:119], v[244:247]
  v_exp_f32 v103, v103
  v_mfma_f32_16x16x32_bf16 v[248:251], a[248:251], v[116:119], v[248:251]
  s_add_u32 s45, s45, 8192
  s_add_u32 m0, s44, 8192
  v_mfma_f32_16x16x32_bf16 v[252:255], a[252:255], v[116:119], v[252:255]
  v_cvt_pk_bf16_f32 v114, v100, v101
  v_cvt_pk_bf16_f32 v115, v102, v103
  v_mfma_f32_16x16x32_bf16 v[76:79], v[32:35], v[116:119], v[76:79]
  ds_read_b128 a[164:167], v3 offset:24576
  v_fma_f32 v104, v104, s40, v21
  v_mfma_f32_16x16x32_bf16 v[96:99], a[128:131], a[32:35], 0
  buffer_load_dwordx4 v14, s[20:23], s45 offen offset:0 lds
  buffer_load_dwordx4 v15, s[20:23], s45 offen offset:1024 lds
  buffer_load_dwordx4 v16, s[20:23], s45 offen offset:2048 lds
  buffer_load_dwordx4 v17, s[20:23], s45 offen offset:3072 lds
  v_mfma_f32_16x16x32_bf16 v[96:99], a[132:135], a[36:39], v[96:99]
  ds_read_b128 a[180:183], v3 offset:28672
  v_fma_f32 v105, v105, s40, v21
  v_mfma_f32_16x16x32_bf16 v[96:99], a[136:139], a[40:43], v[96:99]
  v_exp_f32 v104, v104
  v_mfma_f32_16x16x32_bf16 v[96:99], a[140:143], a[44:47], v[96:99]
  v_exp_f32 v105, v105
  v_mfma_f32_16x16x32_bf16 v[100:103], a[156:159], a[44:47], 0
  ds_read_b64_tr_b16 a[224:225], v6 offset:24576
  v_fma_f32 v106, v106, s40, v21
  v_mfma_f32_16x16x32_bf16 v[100:103], a[152:155], a[40:43], v[100:103]
  ds_read_b64_tr_b16 a[226:227], v6 offset:28672
  v_fma_f32 v107, v107, s40, v21
  v_mfma_f32_16x16x32_bf16 v[100:103], a[148:151], a[36:39], v[100:103]
  buffer_store_dwordx4 v[120:123], v19, s[24:27], s89 offen offset:0 sc0 sc1
  buffer_store_dwordx4 v[124:127], v19, s[24:27], s89 offen offset:1024 sc0 sc1
  v_mfma_f32_16x16x32_bf16 v[100:103], a[144:147], a[32:35], v[100:103]
  v_exp_f32 v106, v106
  v_mfma_f32_16x16x32_bf16 v[128:131], a[192:195], v[112:115], v[128:131]
  v_exp_f32 v107, v107
  v_mfma_f32_16x16x32_bf16 v[132:135], a[196:199], v[112:115], v[132:135]
  v_cvt_pk_bf16_f32 v116, v104, v105
  v_fma_f32 v108, v108, s40, v21
  v_mfma_f32_16x16x32_bf16 v[136:139], a[200:203], v[112:115], v[136:139]
  ds_read_b128 a[168:171], v4 offset:24576
  ds_read_b64_tr_b16 a[228:229], v7 offset:24576
  v_mfma_f32_16x16x32_bf16 v[140:143], a[204:207], v[112:115], v[140:143]
  v_exp_f32 v108, v108
  v_mfma_f32_16x16x32_bf16 v[144:147], a[208:211], v[112:115], v[144:147]
  ds_read_b64_tr_b16 a[230:231], v7 offset:28672
  v_cvt_pk_bf16_f32 v117, v106, v107
  v_mfma_f32_16x16x32_bf16 v[148:151], a[212:215], v[112:115], v[148:151]
  ds_read_b128 a[184:187], v4 offset:28672
  v_fma_f32 v109, v109, s40, v21
  v_mfma_f32_16x16x32_bf16 v[152:155], a[216:219], v[112:115], v[152:155]
  v_exp_f32 v109, v109
  v_mfma_f32_16x16x32_bf16 v[156:159], a[220:223], v[112:115], v[156:159]
  ds_read_b64_tr_b16 a[232:233], v8 offset:24576
  v_fma_f32 v110, v110, s40, v21
  v_fma_f32 v111, v111, s40, v21
  v_exp_f32 v110, v110
  v_exp_f32 v111, v111
  v_mfma_f32_16x16x32_bf16 v[64:67], v[32:35], v[112:115], v[64:67]
  v_cvt_pk_bf16_f32 v118, v108, v109
  v_cvt_pk_bf16_f32 v119, v110, v111
  v_mfma_f32_16x16x32_bf16 v[104:107], a[128:131], a[48:51], 0
  ds_read_b64_tr_b16 a[234:235], v8 offset:28672
  v_fma_f32 v96, v96, s40, v22
  v_mfma_f32_16x16x32_bf16 v[104:107], a[132:135], a[52:55], v[104:107]
  ds_read_b128 a[172:175], v5 offset:24576
  v_fma_f32 v97, v97, s40, v22
  v_mfma_f32_16x16x32_bf16 v[104:107], a[136:139], a[56:59], v[104:107]
  ds_read_b64_tr_b16 a[236:237], v9 offset:24576
  ds_read_b64_tr_b16 a[238:239], v9 offset:28672
  v_mfma_f32_16x16x32_bf16 v[104:107], a[140:143], a[60:63], v[104:107]
  v_exp_f32 v96, v96
  v_mfma_f32_16x16x32_bf16 v[108:111], a[156:159], a[60:63], 0
  v_exp_f32 v97, v97
  v_mfma_f32_16x16x32_bf16 v[108:111], a[152:155], a[56:59], v[108:111]
  v_fma_f32 v98, v98, s40, v22
  v_fma_f32 v99, v99, s40, v22
  v_mfma_f32_16x16x32_bf16 v[108:111], a[148:151], a[52:55], v[108:111]
  v_exp_f32 v98, v98
  v_mfma_f32_16x16x32_bf16 v[108:111], a[144:147], a[48:51], v[108:111]
  v_exp_f32 v99, v99
  v_mfma_f32_16x16x32_bf16 v[160:163], a[192:195], v[116:119], v[160:163]
  ds_read_b128 a[188:191], v5 offset:28672
  ds_read_b64_tr_b16 a[240:241], v10 offset:24576
  v_mfma_f32_16x16x32_bf16 v[164:167], a[196:199], v[116:119], v[164:167]
  v_cvt_pk_bf16_f32 v112, v96, v97
  v_fma_f32 v100, v100, s40, v22
  v_mfma_f32_16x16x32_bf16 v[168:171], a[200:203], v[116:119], v[168:171]
  ds_read_b64_tr_b16 a[242:243], v10 offset:28672
  ds_read_b64_tr_b16 a[244:245], v11 offset:24576
  v_mfma_f32_16x16x32_bf16 v[172:175], a[204:207], v[116:119], v[172:175]
  v_exp_f32 v100, v100
  v_mfma_f32_16x16x32_bf16 v[176:179], a[208:211], v[116:119], v[176:179]
  v_cvt_pk_bf16_f32 v113, v98, v99
  v_fma_f32 v101, v101, s40, v22
  v_mfma_f32_16x16x32_bf16 v[180:183], a[212:215], v[116:119], v[180:183]
  v_exp_f32 v101, v101
  v_mfma_f32_16x16x32_bf16 v[184:187], a[216:219], v[116:119], v[184:187]
  v_fma_f32 v102, v102, s40, v22
  v_fma_f32 v103, v103, s40, v22
  v_mfma_f32_16x16x32_bf16 v[188:191], a[220:223], v[116:119], v[188:191]
  ds_read_b64_tr_b16 a[246:247], v11 offset:28672
  v_exp_f32 v102, v102
  v_exp_f32 v103, v103
  v_mfma_f32_16x16x32_bf16 v[68:71], v[32:35], v[116:119], v[68:71]
  v_cvt_pk_bf16_f32 v114, v100, v101
  v_cvt_pk_bf16_f32 v115, v102, v103
  s_waitcnt lgkmcnt(4)
  v_mfma_f32_16x16x32_bf16 v[96:99], a[160:163], a[0:3], 0
  ds_read_b64_tr_b16 a[248:249], v12 offset:24576
  v_fma_f32 v104, v104, s40, v23
  v_mfma_f32_16x16x32_bf16 v[96:99], a[164:167], a[4:7], v[96:99]
  ds_read_b64_tr_b16 a[250:251], v12 offset:28672
  v_fma_f32 v105, v105, s40, v23
  v_mfma_f32_16x16x32_bf16 v[96:99], a[168:171], a[8:11], v[96:99]
  v_exp_f32 v104, v104
  v_mfma_f32_16x16x32_bf16 v[96:99], a[172:175], a[12:15], v[96:99]
  v_exp_f32 v105, v105
  v_mfma_f32_16x16x32_bf16 v[100:103], a[188:191], a[12:15], 0
  v_fma_f32 v106, v106, s40, v23
  v_fma_f32 v107, v107, s40, v23
  v_mfma_f32_16x16x32_bf16 v[100:103], a[184:187], a[8:11], v[100:103]
  ds_read_b64_tr_b16 a[252:253], v13 offset:24576
  ds_read_b64_tr_b16 a[254:255], v13 offset:28672
  v_mfma_f32_16x16x32_bf16 v[100:103], a[180:183], a[4:7], v[100:103]
  v_exp_f32 v106, v106
  v_mfma_f32_16x16x32_bf16 v[100:103], a[176:179], a[0:3], v[100:103]
  v_exp_f32 v107, v107
  v_mfma_f32_16x16x32_bf16 v[192:195], a[192:195], v[112:115], v[192:195]
  v_cvt_pk_bf16_f32 v116, v104, v105
  v_fma_f32 v108, v108, s40, v23
  v_mfma_f32_16x16x32_bf16 v[196:199], a[196:199], v[112:115], v[196:199]
  v_exp_f32 v108, v108
  v_mfma_f32_16x16x32_bf16 v[200:203], a[200:203], v[112:115], v[200:203]
  v_cvt_pk_bf16_f32 v117, v106, v107
  v_fma_f32 v109, v109, s40, v23
  v_mfma_f32_16x16x32_bf16 v[204:207], a[204:207], v[112:115], v[204:207]
  v_exp_f32 v109, v109
  v_mfma_f32_16x16x32_bf16 v[208:211], a[208:211], v[112:115], v[208:211]
  v_fma_f32 v110, v110, s40, v23
  v_fma_f32 v111, v111, s40, v23
  v_mfma_f32_16x16x32_bf16 v[212:215], a[212:215], v[112:115], v[212:215]
  v_exp_f32 v110, v110
  v_mfma_f32_16x16x32_bf16 v[216:219], a[216:219], v[112:115], v[216:219]
  v_exp_f32 v111, v111
  v_mfma_f32_16x16x32_bf16 v[220:223], a[220:223], v[112:115], v[220:223]
  v_cvt_pk_bf16_f32 v118, v108, v109
  v_cvt_pk_bf16_f32 v119, v110, v111
  v_mfma_f32_16x16x32_bf16 v[72:75], v[32:35], v[112:115], v[72:75]
  v_fma_f32 v96, v96, s40, v20
  v_fma_f32 v97, v97, s40, v20
  v_mfma_f32_16x16x32_bf16 v[104:107], a[160:163], a[16:19], 0
  v_exp_f32 v96, v96
  v_mfma_f32_16x16x32_bf16 v[104:107], a[164:167], a[20:23], v[104:107]
  v_exp_f32 v97, v97
  v_mfma_f32_16x16x32_bf16 v[104:107], a[168:171], a[24:27], v[104:107]
  v_fma_f32 v98, v98, s40, v20
  v_fma_f32 v99, v99, s40, v20
  v_mfma_f32_16x16x32_bf16 v[104:107], a[172:175], a[28:31], v[104:107]
  v_exp_f32 v98, v98
  v_mfma_f32_16x16x32_bf16 v[108:111], a[188:191], a[28:31], 0
  ds_read_b128 a[128:131], v2 offset:32768
  s_add_u32 s45, s45, 8192
  v_mfma_f32_16x16x32_bf16 v[108:111], a[184:187], a[24:27], v[108:111]
  v_exp_f32 v99, v99
  v_mfma_f32_16x16x32_bf16 v[108:111], a[180:183], a[20:23], v[108:111]
  v_cvt_pk_bf16_f32 v112, v96, v97
  v_fma_f32 v100, v100, s40, v20
  v_mfma_f32_16x16x32_bf16 v[108:111], a[176:179], a[16:19], v[108:111]
  v_exp_f32 v100, v100
  v_mfma_f32_16x16x32_bf16 v[224:227], a[192:195], v[116:119], v[224:227]
  v_cvt_pk_bf16_f32 v113, v98, v99
  v_fma_f32 v101, v101, s40, v20
  v_mfma_f32_16x16x32_bf16 v[228:231], a[196:199], v[116:119], v[228:231]
  v_exp_f32 v101, v101
  v_mfma_f32_16x16x32_bf16 v[232:235], a[200:203], v[116:119], v[232:235]
  ds_read_b128 a[144:147], v2 offset:36864
  v_fma_f32 v102, v102, s40, v20
  v_mfma_f32_16x16x32_bf16 v[236:239], a[204:207], v[116:119], v[236:239]
  s_add_u32 m0, s44, 16384
  v_fma_f32 v103, v103, s40, v20
  v_mfma_f32_16x16x32_bf16 v[240:243], a[208:211], v[116:119], v[240:243]
  v_exp_f32 v102, v102
  v_mfma_f32_16x16x32_bf16 v[244:247], a[212:215], v[116:119], v[244:247]
  v_exp_f32 v103, v103
  v_mfma_f32_16x16x32_bf16 v[248:251], a[216:219], v[116:119], v[248:251]
  v_cvt_pk_bf16_f32 v114, v100, v101
  v_cvt_pk_bf16_f32 v115, v102, v103
  v_mfma_f32_16x16x32_bf16 v[252:255], a[220:223], v[116:119], v[252:255]
  ds_read_b128 a[132:135], v3 offset:32768
  v_fma_f32 v104, v104, s40, v21
  v_mfma_f32_16x16x32_bf16 v[76:79], v[32:35], v[116:119], v[76:79]
  ds_read_b128 a[148:151], v3 offset:36864
  v_fma_f32 v105, v105, s40, v21
  v_mfma_f32_16x16x32_bf16 v[96:99], a[160:163], a[32:35], 0
  buffer_load_dwordx4 v14, s[20:23], s45 offen offset:0 lds
  buffer_load_dwordx4 v15, s[20:23], s45 offen offset:1024 lds
  buffer_load_dwordx4 v16, s[20:23], s45 offen offset:2048 lds
  buffer_load_dwordx4 v17, s[20:23], s45 offen offset:3072 lds
  v_mfma_f32_16x16x32_bf16 v[96:99], a[164:167], a[36:39], v[96:99]
  v_exp_f32 v104, v104
  v_mfma_f32_16x16x32_bf16 v[96:99], a[168:171], a[40:43], v[96:99]
  v_exp_f32 v105, v105
  v_mfma_f32_16x16x32_bf16 v[96:99], a[172:175], a[44:47], v[96:99]
  ds_read_b64_tr_b16 a[192:193], v6 offset:32768
  v_fma_f32 v106, v106, s40, v21
  v_mfma_f32_16x16x32_bf16 v[100:103], a[188:191], a[44:47], 0
  ds_read_b64_tr_b16 a[194:195], v6 offset:36864
  v_fma_f32 v107, v107, s40, v21
  v_mfma_f32_16x16x32_bf16 v[100:103], a[184:187], a[40:43], v[100:103]
  v_exp_f32 v106, v106
  v_mfma_f32_16x16x32_bf16 v[100:103], a[180:183], a[36:39], v[100:103]
  buffer_store_dwordx4 v[36:39], v19, s[24:27], s89 offen offset:2048 sc0 sc1
  buffer_store_dwordx4 v[40:43], v19, s[24:27], s89 offen offset:3072 sc0 sc1
  v_mfma_f32_16x16x32_bf16 v[100:103], a[176:179], a[32:35], v[100:103]
  ds_read_b128 a[136:139], v4 offset:32768
  s_waitcnt lgkmcnt(7)
  v_mfma_f32_16x16x32_bf16 v[128:131], a[224:227], v[112:115], v[128:131]
  v_exp_f32 v107, v107
  v_mfma_f32_16x16x32_bf16 v[132:135], a[228:231], v[112:115], v[132:135]
  v_cvt_pk_bf16_f32 v116, v104, v105
  v_fma_f32 v108, v108, s40, v21
  v_mfma_f32_16x16x32_bf16 v[136:139], a[232:235], v[112:115], v[136:139]
  ds_read_b64_tr_b16 a[196:197], v7 offset:32768
  ds_read_b64_tr_b16 a[198:199], v7 offset:36864
  v_mfma_f32_16x16x32_bf16 v[140:143], a[236:239], v[112:115], v[140:143]
  v_exp_f32 v108, v108
  v_mfma_f32_16x16x32_bf16 v[144:147], a[240:243], v[112:115], v[144:147]
  v_cvt_pk_bf16_f32 v117, v106, v107
  v_fma_f32 v109, v109, s40, v21
  v_mfma_f32_16x16x32_bf16 v[148:151], a[244:247], v[112:115], v[148:151]
  v_exp_f32 v109, v109
  v_mfma_f32_16x16x32_bf16 v[152:155], a[248:251], v[112:115], v[152:155]
  v_fma_f32 v110, v110, s40, v21
  v_fma_f32 v111, v111, s40, v21
  v_mfma_f32_16x16x32_bf16 v[156:159], a[252:255], v[112:115], v[156:159]
  ds_read_b128 a[152:155], v4 offset:36864
  ds_read_b64_tr_b16 a[200:201], v8 offset:32768
  v_exp_f32 v110, v110
  v_exp_f32 v111, v111
  v_mfma_f32_16x16x32_bf16 v[64:67], v[32:35], v[112:115], v[64:67]
  v_cvt_pk_bf16_f32 v118, v108, v109
  v_cvt_pk_bf16_f32 v119, v110, v111
  v_mfma_f32_16x16x32_bf16 v[104:107], a[160:163], a[48:51], 0
  ds_read_b64_tr_b16 a[202:203], v8 offset:36864
  v_fma_f32 v96, v96, s40, v22
  v_mfma_f32_16x16x32_bf16 v[104:107], a[164:167], a[52:55], v[104:107]
  ds_read_b128 a[140:143], v5 offset:32768
  v_fma_f32 v97, v97, s40, v22
  v_mfma_f32_16x16x32_bf16 v[104:107], a[168:171], a[56:59], v[104:107]
  ds_read_b64_tr_b16 a[204:205], v9 offset:32768
  ds_read_b64_tr_b16 a[206:207], v9 offset:36864
  v_mfma_f32_16x16x32_bf16 v[104:107], a[172:175], a[60:63], v[104:107]
  v_exp_f32 v96, v96
  v_mfma_f32_16x16x32_bf16 v[108:111], a[188:191], a[60:63], 0
  v_exp_f32 v97, v97
  v_mfma_f32_16x16x32_bf16 v[108:111], a[184:187], a[56:59], v[108:111]
  v_fma_f32 v98, v98, s40, v22
  v_fma_f32 v99, v99, s40, v22
  v_mfma_f32_16x16x32_bf16 v[108:111], a[180:183], a[52:55], v[108:111]
  v_exp_f32 v98, v98
  v_mfma_f32_16x16x32_bf16 v[108:111], a[176:179], a[48:51], v[108:111]
  v_exp_f32 v99, v99
  v_mfma_f32_16x16x32_bf16 v[160:163], a[224:227], v[116:119], v[160:163]
  ds_read_b128 a[156:159], v5 offset:36864
  ds_read_b64_tr_b16 a[208:209], v10 offset:32768
  v_mfma_f32_16x16x32_bf16 v[164:167], a[228:231], v[116:119], v[164:167]
  v_cvt_pk_bf16_f32 v112, v96, v97
  v_fma_f32 v100, v100, s40, v22
  v_mfma_f32_16x16x32_bf16 v[168:171], a[232:235], v[116:119], v[168:171]
  ds_read_b64_tr_b16 a[210:211], v10 offset:36864
  ds_read_b64_tr_b16 a[212:213], v11 offset:32768
  v_mfma_f32_16x16x32_bf16 v[172:175], a[236:239], v[116:119], v[172:175]
  v_exp_f32 v100, v100
  v_mfma_f32_16x16x32_bf16 v[176:179], a[240:243], v[116:119], v[176:179]
  v_cvt_pk_bf16_f32 v113, v98, v99
  v_fma_f32 v101, v101, s40, v22
  v_mfma_f32_16x16x32_bf16 v[180:183], a[244:247], v[116:119], v[180:183]
  v_exp_f32 v101, v101
  v_mfma_f32_16x16x32_bf16 v[184:187], a[248:251], v[116:119], v[184:187]
  v_fma_f32 v102, v102, s40, v22
  v_fma_f32 v103, v103, s40, v22
  v_mfma_f32_16x16x32_bf16 v[188:191], a[252:255], v[116:119], v[188:191]
  ds_read_b64_tr_b16 a[214:215], v11 offset:36864
  v_exp_f32 v102, v102
  v_exp_f32 v103, v103
  v_mfma_f32_16x16x32_bf16 v[68:71], v[32:35], v[116:119], v[68:71]
  v_cvt_pk_bf16_f32 v114, v100, v101
  v_cvt_pk_bf16_f32 v115, v102, v103
  s_waitcnt lgkmcnt(4)
  v_mfma_f32_16x16x32_bf16 v[96:99], a[128:131], a[0:3], 0
  ds_read_b64_tr_b16 a[216:217], v12 offset:32768
  v_fma_f32 v104, v104, s40, v23
  v_mfma_f32_16x16x32_bf16 v[96:99], a[132:135], a[4:7], v[96:99]
  ds_read_b64_tr_b16 a[218:219], v12 offset:36864
  v_fma_f32 v105, v105, s40, v23
  v_mfma_f32_16x16x32_bf16 v[96:99], a[136:139], a[8:11], v[96:99]
  v_exp_f32 v104, v104
  v_mfma_f32_16x16x32_bf16 v[96:99], a[140:143], a[12:15], v[96:99]
  v_exp_f32 v105, v105
  v_mfma_f32_16x16x32_bf16 v[100:103], a[156:159], a[12:15], 0
  v_fma_f32 v106, v106, s40, v23
  v_fma_f32 v107, v107, s40, v23
  v_mfma_f32_16x16x32_bf16 v[100:103], a[152:155], a[8:11], v[100:103]
  ds_read_b64_tr_b16 a[220:221], v13 offset:32768
  ds_read_b64_tr_b16 a[222:223], v13 offset:36864
  v_mfma_f32_16x16x32_bf16 v[100:103], a[148:151], a[4:7], v[100:103]
  v_exp_f32 v106, v106
  v_mfma_f32_16x16x32_bf16 v[100:103], a[144:147], a[0:3], v[100:103]
  v_exp_f32 v107, v107
  v_mfma_f32_16x16x32_bf16 v[192:195], a[224:227], v[112:115], v[192:195]
  v_cvt_pk_bf16_f32 v116, v104, v105
  v_fma_f32 v108, v108, s40, v23
  v_mfma_f32_16x16x32_bf16 v[196:199], a[228:231], v[112:115], v[196:199]
  v_exp_f32 v108, v108
  v_mfma_f32_16x16x32_bf16 v[200:203], a[232:235], v[112:115], v[200:203]
  v_cvt_pk_bf16_f32 v117, v106, v107
  v_fma_f32 v109, v109, s40, v23
  v_mfma_f32_16x16x32_bf16 v[204:207], a[236:239], v[112:115], v[204:207]
  v_exp_f32 v109, v109
  v_mfma_f32_16x16x32_bf16 v[208:211], a[240:243], v[112:115], v[208:211]
  v_fma_f32 v110, v110, s40, v23
  v_fma_f32 v111, v111, s40, v23
  v_mfma_f32_16x16x32_bf16 v[212:215], a[244:247], v[112:115], v[212:215]
  v_exp_f32 v110, v110
  v_mfma_f32_16x16x32_bf16 v[216:219], a[248:251], v[112:115], v[216:219]
  v_exp_f32 v111, v111
  v_mfma_f32_16x16x32_bf16 v[220:223], a[252:255], v[112:115], v[220:223]
  v_cvt_pk_bf16_f32 v118, v108, v109
  v_cvt_pk_bf16_f32 v119, v110, v111
  v_mfma_f32_16x16x32_bf16 v[72:75], v[32:35], v[112:115], v[72:75]
  s_waitcnt vmcnt(20) lgkmcnt(0)
  s_barrier
  v_mfma_f32_16x16x32_bf16 v[104:107], a[128:131], a[16:19], 0
  v_fma_f32 v96, v96, s40, v20
  v_fma_f32 v97, v97, s40, v20
  v_mfma_f32_16x16x32_bf16 v[104:107], a[132:135], a[20:23], v[104:107]
  v_exp_f32 v96, v96
  v_mfma_f32_16x16x32_bf16 v[104:107], a[136:139], a[24:27], v[104:107]
  v_exp_f32 v97, v97
  v_mfma_f32_16x16x32_bf16 v[104:107], a[140:143], a[28:31], v[104:107]
  v_fma_f32 v98, v98, s40, v20
  v_fma_f32 v99, v99, s40, v20
  v_mfma_f32_16x16x32_bf16 v[108:111], a[156:159], a[28:31], 0
  v_exp_f32 v98, v98
  v_mfma_f32_16x16x32_bf16 v[108:111], a[152:155], a[24:27], v[108:111]
  ds_read_b128 a[160:163], v2 offset:40960
  ds_read_b128 a[176:179], v2 offset:45056
  v_mfma_f32_16x16x32_bf16 v[108:111], a[148:151], a[20:23], v[108:111]
  v_exp_f32 v99, v99
  v_mfma_f32_16x16x32_bf16 v[108:111], a[144:147], a[16:19], v[108:111]
  v_cvt_pk_bf16_f32 v112, v96, v97
  v_fma_f32 v100, v100, s40, v20
  v_mfma_f32_16x16x32_bf16 v[224:227], a[224:227], v[116:119], v[224:227]
  v_exp_f32 v100, v100
  v_mfma_f32_16x16x32_bf16 v[228:231], a[228:231], v[116:119], v[228:231]
  v_cvt_pk_bf16_f32 v113, v98, v99
  v_fma_f32 v101, v101, s40, v20
  v_mfma_f32_16x16x32_bf16 v[232:235], a[232:235], v[116:119], v[232:235]
  v_exp_f32 v101, v101
  v_mfma_f32_16x16x32_bf16 v[236:239], a[236:239], v[116:119], v[236:239]
  v_fma_f32 v102, v102, s40, v20
  v_fma_f32 v103, v103, s40, v20
  v_mfma_f32_16x16x32_bf16 v[240:243], a[240:243], v[116:119], v[240:243]
  v_exp_f32 v102, v102
  v_mfma_f32_16x16x32_bf16 v[244:247], a[244:247], v[116:119], v[244:247]
  v_exp_f32 v103, v103
  v_mfma_f32_16x16x32_bf16 v[248:251], a[248:251], v[116:119], v[248:251]
  s_add_u32 s45, s45, 8192
  s_add_u32 m0, s44, 24576
  v_mfma_f32_16x16x32_bf16 v[252:255], a[252:255], v[116:119], v[252:255]
  v_cvt_pk_bf16_f32 v114, v100, v101
  v_cvt_pk_bf16_f32 v115, v102, v103
  v_mfma_f32_16x16x32_bf16 v[76:79], v[32:35], v[116:119], v[76:79]
  ds_read_b128 a[164:167], v3 offset:40960
  v_fma_f32 v104, v104, s40, v21
  v_mfma_f32_16x16x32_bf16 v[96:99], a[128:131], a[32:35], 0
  buffer_load_dwordx4 v14, s[20:23], s45 offen offset:0 lds
  buffer_load_dwordx4 v15, s[20:23], s45 offen offset:1024 lds
  buffer_load_dwordx4 v16, s[20:23], s45 offen offset:2048 lds
  buffer_load_dwordx4 v17, s[20:23], s45 offen offset:3072 lds
  v_mfma_f32_16x16x32_bf16 v[96:99], a[132:135], a[36:39], v[96:99]
  ds_read_b128 a[180:183], v3 offset:45056
  v_fma_f32 v105, v105, s40, v21
  v_mfma_f32_16x16x32_bf16 v[96:99], a[136:139], a[40:43], v[96:99]
  v_exp_f32 v104, v104
  v_mfma_f32_16x16x32_bf16 v[96:99], a[140:143], a[44:47], v[96:99]
  v_exp_f32 v105, v105
  v_mfma_f32_16x16x32_bf16 v[100:103], a[156:159], a[44:47], 0
  ds_read_b64_tr_b16 a[224:225], v6 offset:40960
  v_fma_f32 v106, v106, s40, v21
  v_mfma_f32_16x16x32_bf16 v[100:103], a[152:155], a[40:43], v[100:103]
  ds_read_b64_tr_b16 a[226:227], v6 offset:45056
  v_fma_f32 v107, v107, s40, v21
  v_mfma_f32_16x16x32_bf16 v[100:103], a[148:151], a[36:39], v[100:103]
  buffer_store_dwordx4 a[96:99], v19, s[24:27], s90 offen offset:0 sc0 sc1
  buffer_store_dwordx4 a[100:103], v19, s[24:27], s90 offen offset:1024 sc0 sc1
  v_mfma_f32_16x16x32_bf16 v[100:103], a[144:147], a[32:35], v[100:103]
  v_exp_f32 v106, v106
  v_mfma_f32_16x16x32_bf16 v[128:131], a[192:195], v[112:115], v[128:131]
  v_exp_f32 v107, v107
  v_mfma_f32_16x16x32_bf16 v[132:135], a[196:199], v[112:115], v[132:135]
  v_cvt_pk_bf16_f32 v116, v104, v105
  v_fma_f32 v108, v108, s40, v21
  v_mfma_f32_16x16x32_bf16 v[136:139], a[200:203], v[112:115], v[136:139]
  ds_read_b128 a[168:171], v4 offset:40960
  ds_read_b64_tr_b16 a[228:229], v7 offset:40960
  v_mfma_f32_16x16x32_bf16 v[140:143], a[204:207], v[112:115], v[140:143]
  v_exp_f32 v108, v108
  v_mfma_f32_16x16x32_bf16 v[144:147], a[208:211], v[112:115], v[144:147]
  ds_read_b64_tr_b16 a[230:231], v7 offset:45056
  v_cvt_pk_bf16_f32 v117, v106, v107
  v_mfma_f32_16x16x32_bf16 v[148:151], a[212:215], v[112:115], v[148:151]
  ds_read_b128 a[184:187], v4 offset:45056
  v_fma_f32 v109, v109, s40, v21
  v_mfma_f32_16x16x32_bf16 v[152:155], a[216:219], v[112:115], v[152:155]
  v_exp_f32 v109, v109
  v_mfma_f32_16x16x32_bf16 v[156:159], a[220:223], v[112:115], v[156:159]
  ds_read_b64_tr_b16 a[232:233], v8 offset:40960
  v_fma_f32 v110, v110, s40, v21
  v_fma_f32 v111, v111, s40, v21
  v_exp_f32 v110, v110
  v_exp_f32 v111, v111
  v_mfma_f32_16x16x32_bf16 v[64:67], v[32:35], v[112:115], v[64:67]
  v_cvt_pk_bf16_f32 v118, v108, v109
  v_cvt_pk_bf16_f32 v119, v110, v111
  v_mfma_f32_16x16x32_bf16 v[104:107], a[128:131], a[48:51], 0
  ds_read_b64_tr_b16 a[234:235], v8 offset:45056
  v_fma_f32 v96, v96, s40, v22
  v_mfma_f32_16x16x32_bf16 v[104:107], a[132:135], a[52:55], v[104:107]
  ds_read_b128 a[172:175], v5 offset:40960
  v_fma_f32 v97, v97, s40, v22
  v_mfma_f32_16x16x32_bf16 v[104:107], a[136:139], a[56:59], v[104:107]
  ds_read_b64_tr_b16 a[236:237], v9 offset:40960
  ds_read_b64_tr_b16 a[238:239], v9 offset:45056
  v_mfma_f32_16x16x32_bf16 v[104:107], a[140:143], a[60:63], v[104:107]
  v_exp_f32 v96, v96
  v_mfma_f32_16x16x32_bf16 v[108:111], a[156:159], a[60:63], 0
  v_exp_f32 v97, v97
  v_mfma_f32_16x16x32_bf16 v[108:111], a[152:155], a[56:59], v[108:111]
  v_fma_f32 v98, v98, s40, v22
  v_fma_f32 v99, v99, s40, v22
  v_mfma_f32_16x16x32_bf16 v[108:111], a[148:151], a[52:55], v[108:111]
  v_exp_f32 v98, v98
  v_mfma_f32_16x16x32_bf16 v[108:111], a[144:147], a[48:51], v[108:111]
  v_exp_f32 v99, v99
  v_mfma_f32_16x16x32_bf16 v[160:163], a[192:195], v[116:119], v[160:163]
  ds_read_b128 a[188:191], v5 offset:45056
  ds_read_b64_tr_b16 a[240:241], v10 offset:40960
  v_mfma_f32_16x16x32_bf16 v[164:167], a[196:199], v[116:119], v[164:167]
  v_cvt_pk_bf16_f32 v112, v96, v97
  v_fma_f32 v100, v100, s40, v22
  v_mfma_f32_16x16x32_bf16 v[168:171], a[200:203], v[116:119], v[168:171]
  ds_read_b64_tr_b16 a[242:243], v10 offset:45056
  ds_read_b64_tr_b16 a[244:245], v11 offset:40960
  v_mfma_f32_16x16x32_bf16 v[172:175], a[204:207], v[116:119], v[172:175]
  v_exp_f32 v100, v100
  v_mfma_f32_16x16x32_bf16 v[176:179], a[208:211], v[116:119], v[176:179]
  v_cvt_pk_bf16_f32 v113, v98, v99
  v_fma_f32 v101, v101, s40, v22
  v_mfma_f32_16x16x32_bf16 v[180:183], a[212:215], v[116:119], v[180:183]
  v_exp_f32 v101, v101
  v_mfma_f32_16x16x32_bf16 v[184:187], a[216:219], v[116:119], v[184:187]
  v_fma_f32 v102, v102, s40, v22
  v_fma_f32 v103, v103, s40, v22
  v_mfma_f32_16x16x32_bf16 v[188:191], a[220:223], v[116:119], v[188:191]
  ds_read_b64_tr_b16 a[246:247], v11 offset:45056
  v_exp_f32 v102, v102
  v_exp_f32 v103, v103
  v_mfma_f32_16x16x32_bf16 v[68:71], v[32:35], v[116:119], v[68:71]
  v_cvt_pk_bf16_f32 v114, v100, v101
  v_cvt_pk_bf16_f32 v115, v102, v103
  s_waitcnt lgkmcnt(4)
  v_mfma_f32_16x16x32_bf16 v[96:99], a[160:163], a[0:3], 0
  ds_read_b64_tr_b16 a[248:249], v12 offset:40960
  v_fma_f32 v104, v104, s40, v23
  v_mfma_f32_16x16x32_bf16 v[96:99], a[164:167], a[4:7], v[96:99]
  ds_read_b64_tr_b16 a[250:251], v12 offset:45056
  v_fma_f32 v105, v105, s40, v23
  v_mfma_f32_16x16x32_bf16 v[96:99], a[168:171], a[8:11], v[96:99]
  v_exp_f32 v104, v104
  v_mfma_f32_16x16x32_bf16 v[96:99], a[172:175], a[12:15], v[96:99]
  v_exp_f32 v105, v105
  v_mfma_f32_16x16x32_bf16 v[100:103], a[188:191], a[12:15], 0
  v_fma_f32 v106, v106, s40, v23
  v_fma_f32 v107, v107, s40, v23
  v_mfma_f32_16x16x32_bf16 v[100:103], a[184:187], a[8:11], v[100:103]
  ds_read_b64_tr_b16 a[252:253], v13 offset:40960
  ds_read_b64_tr_b16 a[254:255], v13 offset:45056
  v_mfma_f32_16x16x32_bf16 v[100:103], a[180:183], a[4:7], v[100:103]
  v_exp_f32 v106, v106
  v_mfma_f32_16x16x32_bf16 v[100:103], a[176:179], a[0:3], v[100:103]
  v_exp_f32 v107, v107
  v_mfma_f32_16x16x32_bf16 v[192:195], a[192:195], v[112:115], v[192:195]
  v_cvt_pk_bf16_f32 v116, v104, v105
  v_fma_f32 v108, v108, s40, v23
  v_mfma_f32_16x16x32_bf16 v[196:199], a[196:199], v[112:115], v[196:199]
  v_exp_f32 v108, v108
  v_mfma_f32_16x16x32_bf16 v[200:203], a[200:203], v[112:115], v[200:203]
  v_cvt_pk_bf16_f32 v117, v106, v107
  v_fma_f32 v109, v109, s40, v23
  v_mfma_f32_16x16x32_bf16 v[204:207], a[204:207], v[112:115], v[204:207]
  v_exp_f32 v109, v109
  v_mfma_f32_16x16x32_bf16 v[208:211], a[208:211], v[112:115], v[208:211]
  v_fma_f32 v110, v110, s40, v23
  v_fma_f32 v111, v111, s40, v23
  v_mfma_f32_16x16x32_bf16 v[212:215], a[212:215], v[112:115], v[212:215]
  v_exp_f32 v110, v110
  v_mfma_f32_16x16x32_bf16 v[216:219], a[216:219], v[112:115], v[216:219]
  v_exp_f32 v111, v111
  v_mfma_f32_16x16x32_bf16 v[220:223], a[220:223], v[112:115], v[220:223]
  v_cvt_pk_bf16_f32 v118, v108, v109
  v_cvt_pk_bf16_f32 v119, v110, v111
  v_mfma_f32_16x16x32_bf16 v[72:75], v[32:35], v[112:115], v[72:75]
  v_fma_f32 v96, v96, s40, v20
  v_fma_f32 v97, v97, s40, v20
  v_mfma_f32_16x16x32_bf16 v[104:107], a[160:163], a[16:19], 0
  v_exp_f32 v96, v96
  v_mfma_f32_16x16x32_bf16 v[104:107], a[164:167], a[20:23], v[104:107]
  v_exp_f32 v97, v97
  v_mfma_f32_16x16x32_bf16 v[104:107], a[168:171], a[24:27], v[104:107]
  v_fma_f32 v98, v98, s40, v20
  v_fma_f32 v99, v99, s40, v20
  v_mfma_f32_16x16x32_bf16 v[104:107], a[172:175], a[28:31], v[104:107]
  v_exp_f32 v98, v98
  v_mfma_f32_16x16x32_bf16 v[108:111], a[188:191], a[28:31], 0
  ds_read_b128 a[128:131], v2 offset:49152
  s_add_u32 s45, s45, 8192
  v_mfma_f32_16x16x32_bf16 v[108:111], a[184:187], a[24:27], v[108:111]
  v_exp_f32 v99, v99
  v_mfma_f32_16x16x32_bf16 v[108:111], a[180:183], a[20:23], v[108:111]
  v_cvt_pk_bf16_f32 v112, v96, v97
  v_fma_f32 v100, v100, s40, v20
  v_mfma_f32_16x16x32_bf16 v[108:111], a[176:179], a[16:19], v[108:111]
  v_exp_f32 v100, v100
  v_mfma_f32_16x16x32_bf16 v[224:227], a[192:195], v[116:119], v[224:227]
  v_cvt_pk_bf16_f32 v113, v98, v99
  v_fma_f32 v101, v101, s40, v20
  v_mfma_f32_16x16x32_bf16 v[228:231], a[196:199], v[116:119], v[228:231]
  v_exp_f32 v101, v101
  v_mfma_f32_16x16x32_bf16 v[232:235], a[200:203], v[116:119], v[232:235]
  ds_read_b128 a[144:147], v2 offset:53248
  v_fma_f32 v102, v102, s40, v20
  v_mfma_f32_16x16x32_bf16 v[236:239], a[204:207], v[116:119], v[236:239]
  s_add_u32 m0, s44, 32768
  v_fma_f32 v103, v103, s40, v20
  v_mfma_f32_16x16x32_bf16 v[240:243], a[208:211], v[116:119], v[240:243]
  v_exp_f32 v102, v102
  v_mfma_f32_16x16x32_bf16 v[244:247], a[212:215], v[116:119], v[244:247]
  v_exp_f32 v103, v103
  v_mfma_f32_16x16x32_bf16 v[248:251], a[216:219], v[116:119], v[248:251]
  v_cvt_pk_bf16_f32 v114, v100, v101
  v_cvt_pk_bf16_f32 v115, v102, v103
  v_mfma_f32_16x16x32_bf16 v[252:255], a[220:223], v[116:119], v[252:255]
  ds_read_b128 a[132:135], v3 offset:49152
  v_fma_f32 v104, v104, s40, v21
  v_mfma_f32_16x16x32_bf16 v[76:79], v[32:35], v[116:119], v[76:79]
  ds_read_b128 a[148:151], v3 offset:53248
  v_fma_f32 v105, v105, s40, v21
  v_mfma_f32_16x16x32_bf16 v[96:99], a[160:163], a[32:35], 0
  buffer_load_dwordx4 v14, s[20:23], s45 offen offset:0 lds
  buffer_load_dwordx4 v15, s[20:23], s45 offen offset:1024 lds
  buffer_load_dwordx4 v16, s[20:23], s45 offen offset:2048 lds
  buffer_load_dwordx4 v17, s[20:23], s45 offen offset:3072 lds
  v_mfma_f32_16x16x32_bf16 v[96:99], a[164:167], a[36:39], v[96:99]
  v_exp_f32 v104, v104
  v_mfma_f32_16x16x32_bf16 v[96:99], a[168:171], a[40:43], v[96:99]
  v_exp_f32 v105, v105
  v_mfma_f32_16x16x32_bf16 v[96:99], a[172:175], a[44:47], v[96:99]
  ds_read_b64_tr_b16 a[192:193], v6 offset:49152
  v_fma_f32 v106, v106, s40, v21
  v_mfma_f32_16x16x32_bf16 v[100:103], a[188:191], a[44:47], 0
  ds_read_b64_tr_b16 a[194:195], v6 offset:53248
  v_fma_f32 v107, v107, s40, v21
  v_mfma_f32_16x16x32_bf16 v[100:103], a[184:187], a[40:43], v[100:103]
  v_exp_f32 v106, v106
  v_mfma_f32_16x16x32_bf16 v[100:103], a[180:183], a[36:39], v[100:103]
  v_exp_f32 v107, v107
  v_mfma_f32_16x16x32_bf16 v[100:103], a[176:179], a[32:35], v[100:103]
  v_cvt_pk_bf16_f32 v116, v104, v105
  s_waitcnt lgkmcnt(6)
  v_mfma_f32_16x16x32_bf16 v[128:131], a[224:227], v[112:115], v[128:131]
  ds_read_b128 a[136:139], v4 offset:49152
  v_fma_f32 v108, v108, s40, v21
  v_mfma_f32_16x16x32_bf16 v[132:135], a[228:231], v[112:115], v[132:135]
  v_exp_f32 v108, v108
  v_mfma_f32_16x16x32_bf16 v[136:139], a[232:235], v[112:115], v[136:139]
  ds_read_b64_tr_b16 a[196:197], v7 offset:49152
  v_cvt_pk_bf16_f32 v117, v106, v107
  v_mfma_f32_16x16x32_bf16 v[140:143], a[236:239], v[112:115], v[140:143]
  ds_read_b64_tr_b16 a[198:199], v7 offset:53248
  v_fma_f32 v109, v109, s40, v21
  v_mfma_f32_16x16x32_bf16 v[144:147], a[240:243], v[112:115], v[144:147]
  v_exp_f32 v109, v109
  v_mfma_f32_16x16x32_bf16 v[148:151], a[244:247], v[112:115], v[148:151]
  v_fma_f32 v110, v110, s40, v21
  v_fma_f32 v111, v111, s40, v21
  v_mfma_f32_16x16x32_bf16 v[152:155], a[248:251], v[112:115], v[152:155]
  v_exp_f32 v110, v110
  v_mfma_f32_16x16x32_bf16 v[156:159], a[252:255], v[112:115], v[156:159]
  ds_read_b128 a[152:155], v4 offset:53248
  ds_read_b64_tr_b16 a[200:201], v8 offset:49152
  v_exp_f32 v111, v111
  v_mfma_f32_16x16x32_bf16 v[64:67], v[32:35], v[112:115], v[64:67]
  v_cvt_pk_bf16_f32 v118, v108, v109
  v_cvt_pk_bf16_f32 v119, v110, v111
  v_mfma_f32_16x16x32_bf16 v[104:107], a[160:163], a[48:51], 0
  ds_read_b64_tr_b16 a[202:203], v8 offset:53248
  v_fma_f32 v96, v96, s40, v22
  v_mfma_f32_16x16x32_bf16 v[104:107], a[164:167], a[52:55], v[104:107]
  ds_read_b128 a[140:143], v5 offset:49152
  v_fma_f32 v97, v97, s40, v22
  v_mfma_f32_16x16x32_bf16 v[104:107], a[168:171], a[56:59], v[104:107]
  ds_read_b64_tr_b16 a[204:205], v9 offset:49152
  ds_read_b64_tr_b16 a[206:207], v9 offset:53248
  v_mfma_f32_16x16x32_bf16 v[104:107], a[172:175], a[60:63], v[104:107]
  v_exp_f32 v96, v96
  v_mfma_f32_16x16x32_bf16 v[108:111], a[188:191], a[60:63], 0
  v_exp_f32 v97, v97
  v_mfma_f32_16x16x32_bf16 v[108:111], a[184:187], a[56:59], v[108:111]
  v_fma_f32 v98, v98, s40, v22
  v_fma_f32 v99, v99, s40, v22
  v_mfma_f32_16x16x32_bf16 v[108:111], a[180:183], a[52:55], v[108:111]
  v_exp_f32 v98, v98
  v_mfma_f32_16x16x32_bf16 v[108:111], a[176:179], a[48:51], v[108:111]
  v_exp_f32 v99, v99
  v_mfma_f32_16x16x32_bf16 v[160:163], a[224:227], v[116:119], v[160:163]
  ds_read_b128 a[156:159], v5 offset:53248
  ds_read_b64_tr_b16 a[208:209], v10 offset:49152
  v_mfma_f32_16x16x32_bf16 v[164:167], a[228:231], v[116:119], v[164:167]
  v_cvt_pk_bf16_f32 v112, v96, v97
  v_fma_f32 v100, v100, s40, v22
  v_mfma_f32_16x16x32_bf16 v[168:171], a[232:235], v[116:119], v[168:171]
  ds_read_b64_tr_b16 a[210:211], v10 offset:53248
  ds_read_b64_tr_b16 a[212:213], v11 offset:49152
  v_mfma_f32_16x16x32_bf16 v[172:175], a[236:239], v[116:119], v[172:175]
  v_exp_f32 v100, v100
  v_mfma_f32_16x16x32_bf16 v[176:179], a[240:243], v[116:119], v[176:179]
  v_cvt_pk_bf16_f32 v113, v98, v99
  v_fma_f32 v101, v101, s40, v22
  v_mfma_f32_16x16x32_bf16 v[180:183], a[244:247], v[116:119], v[180:183]
  v_exp_f32 v101, v101
  v_mfma_f32_16x16x32_bf16 v[184:187], a[248:251], v[116:119], v[184:187]
  v_fma_f32 v102, v102, s40, v22
  v_fma_f32 v103, v103, s40, v22
  v_mfma_f32_16x16x32_bf16 v[188:191], a[252:255], v[116:119], v[188:191]
  ds_read_b64_tr_b16 a[214:215], v11 offset:53248
  v_exp_f32 v102, v102
  v_exp_f32 v103, v103
  v_mfma_f32_16x16x32_bf16 v[68:71], v[32:35], v[116:119], v[68:71]
  v_cvt_pk_bf16_f32 v114, v100, v101
  v_cvt_pk_bf16_f32 v115, v102, v103
  s_waitcnt lgkmcnt(4)
  v_mfma_f32_16x16x32_bf16 v[96:99], a[128:131], a[0:3], 0
  ds_read_b64_tr_b16 a[216:217], v12 offset:49152
  v_fma_f32 v104, v104, s40, v23
  v_mfma_f32_16x16x32_bf16 v[96:99], a[132:135], a[4:7], v[96:99]
  ds_read_b64_tr_b16 a[218:219], v12 offset:53248
  v_fma_f32 v105, v105, s40, v23
  v_mfma_f32_16x16x32_bf16 v[96:99], a[136:139], a[8:11], v[96:99]
  v_exp_f32 v104, v104
  v_mfma_f32_16x16x32_bf16 v[96:99], a[140:143], a[12:15], v[96:99]
  v_exp_f32 v105, v105
  v_mfma_f32_16x16x32_bf16 v[100:103], a[156:159], a[12:15], 0
  v_fma_f32 v106, v106, s40, v23
  v_fma_f32 v107, v107, s40, v23
  v_mfma_f32_16x16x32_bf16 v[100:103], a[152:155], a[8:11], v[100:103]
  ds_read_b64_tr_b16 a[220:221], v13 offset:49152
  ds_read_b64_tr_b16 a[222:223], v13 offset:53248
  v_mfma_f32_16x16x32_bf16 v[100:103], a[148:151], a[4:7], v[100:103]
  v_exp_f32 v106, v106
  v_mfma_f32_16x16x32_bf16 v[100:103], a[144:147], a[0:3], v[100:103]
  v_exp_f32 v107, v107
  v_mfma_f32_16x16x32_bf16 v[192:195], a[224:227], v[112:115], v[192:195]
  v_cvt_pk_bf16_f32 v116, v104, v105
  v_fma_f32 v108, v108, s40, v23
  v_mfma_f32_16x16x32_bf16 v[196:199], a[228:231], v[112:115], v[196:199]
  v_exp_f32 v108, v108
  v_mfma_f32_16x16x32_bf16 v[200:203], a[232:235], v[112:115], v[200:203]
  v_cvt_pk_bf16_f32 v117, v106, v107
  v_fma_f32 v109, v109, s40, v23
  v_mfma_f32_16x16x32_bf16 v[204:207], a[236:239], v[112:115], v[204:207]
  v_exp_f32 v109, v109
  v_mfma_f32_16x16x32_bf16 v[208:211], a[240:243], v[112:115], v[208:211]
  s_add_u32 s67, s48, s81
  v_fma_f32 v110, v110, s40, v23
  v_mfma_f32_16x16x32_bf16 v[212:215], a[244:247], v[112:115], v[212:215]
  s_add_u32 m0, s80, 0
  v_fma_f32 v111, v111, s40, v23
  v_mfma_f32_16x16x32_bf16 v[216:219], a[248:251], v[112:115], v[216:219]
  v_exp_f32 v110, v110
  v_mfma_f32_16x16x32_bf16 v[220:223], a[252:255], v[112:115], v[220:223]
  v_exp_f32 v111, v111
  v_mfma_f32_16x16x32_bf16 v[72:75], v[32:35], v[112:115], v[72:75]
  buffer_load_dwordx4 v48, s[16:19], s67 offen offset:0 nt lds
  buffer_load_dwordx4 v49, s[16:19], s67 offen offset:1024 nt lds
  v_cvt_pk_bf16_f32 v118, v108, v109
  v_cvt_pk_bf16_f32 v119, v110, v111
  s_waitcnt vmcnt(24) lgkmcnt(0)
  s_barrier
  v_mfma_f32_16x16x32_bf16 v[104:107], a[128:131], a[16:19], 0
  v_fma_f32 v96, v96, s40, v20
  v_fma_f32 v97, v97, s40, v20
  v_mfma_f32_16x16x32_bf16 v[104:107], a[132:135], a[20:23], v[104:107]
  v_exp_f32 v96, v96
  v_mfma_f32_16x16x32_bf16 v[104:107], a[136:139], a[24:27], v[104:107]
  v_exp_f32 v97, v97
  v_mfma_f32_16x16x32_bf16 v[104:107], a[140:143], a[28:31], v[104:107]
  v_fma_f32 v98, v98, s40, v20
  v_fma_f32 v99, v99, s40, v20
  v_mfma_f32_16x16x32_bf16 v[108:111], a[156:159], a[28:31], 0
  v_exp_f32 v98, v98
  v_mfma_f32_16x16x32_bf16 v[108:111], a[152:155], a[24:27], v[108:111]
  ds_read_b128 a[160:163], v2 offset:57344
  ds_read_b128 a[176:179], v2 offset:61440
  v_mfma_f32_16x16x32_bf16 v[108:111], a[148:151], a[20:23], v[108:111]
  v_exp_f32 v99, v99
  v_mfma_f32_16x16x32_bf16 v[108:111], a[144:147], a[16:19], v[108:111]
  v_cvt_pk_bf16_f32 v112, v96, v97
  v_fma_f32 v100, v100, s40, v20
  v_mfma_f32_16x16x32_bf16 v[224:227], a[224:227], v[116:119], v[224:227]
  v_exp_f32 v100, v100
  v_mfma_f32_16x16x32_bf16 v[228:231], a[228:231], v[116:119], v[228:231]
  v_cvt_pk_bf16_f32 v113, v98, v99
  v_fma_f32 v101, v101, s40, v20
  v_mfma_f32_16x16x32_bf16 v[232:235], a[232:235], v[116:119], v[232:235]
  v_exp_f32 v101, v101
  v_mfma_f32_16x16x32_bf16 v[236:239], a[236:239], v[116:119], v[236:239]
  v_fma_f32 v102, v102, s40, v20
  v_fma_f32 v103, v103, s40, v20
  v_mfma_f32_16x16x32_bf16 v[240:243], a[240:243], v[116:119], v[240:243]
  v_exp_f32 v102, v102
  v_mfma_f32_16x16x32_bf16 v[244:247], a[244:247], v[116:119], v[244:247]
  v_exp_f32 v103, v103
  v_mfma_f32_16x16x32_bf16 v[248:251], a[248:251], v[116:119], v[248:251]
  s_add_u32 s45, s45, 8192
  s_add_u32 m0, s44, 40960
  v_mfma_f32_16x16x32_bf16 v[252:255], a[252:255], v[116:119], v[252:255]
  v_cvt_pk_bf16_f32 v114, v100, v101
  v_cvt_pk_bf16_f32 v115, v102, v103
  v_mfma_f32_16x16x32_bf16 v[76:79], v[32:35], v[116:119], v[76:79]
  ds_read_b128 a[164:167], v3 offset:57344
  v_fma_f32 v104, v104, s40, v21
  v_mfma_f32_16x16x32_bf16 v[96:99], a[128:131], a[32:35], 0
  buffer_load_dwordx4 v14, s[20:23], s45 offen offset:0 lds
  buffer_load_dwordx4 v15, s[20:23], s45 offen offset:1024 lds
  buffer_load_dwordx4 v16, s[20:23], s45 offen offset:2048 lds
  buffer_load_dwordx4 v17, s[20:23], s45 offen offset:3072 lds
  v_mfma_f32_16x16x32_bf16 v[96:99], a[132:135], a[36:39], v[96:99]
  ds_read_b128 a[180:183], v3 offset:61440
  v_fma_f32 v105, v105, s40, v21
  v_mfma_f32_16x16x32_bf16 v[96:99], a[136:139], a[40:43], v[96:99]
  v_exp_f32 v104, v104
  v_mfma_f32_16x16x32_bf16 v[96:99], a[140:143], a[44:47], v[96:99]
  v_exp_f32 v105, v105
  v_mfma_f32_16x16x32_bf16 v[100:103], a[156:159], a[44:47], 0
  ds_read_b64_tr_b16 a[224:225], v6 offset:57344
  v_fma_f32 v106, v106, s40, v21
  v_mfma_f32_16x16x32_bf16 v[100:103], a[152:155], a[40:43], v[100:103]
  ds_read_b64_tr_b16 a[226:227], v6 offset:61440
  v_fma_f32 v107, v107, s40, v21
  v_mfma_f32_16x16x32_bf16 v[100:103], a[148:151], a[36:39], v[100:103]
  v_exp_f32 v106, v106
  v_mfma_f32_16x16x32_bf16 v[100:103], a[144:147], a[32:35], v[100:103]
  v_exp_f32 v107, v107
  v_mfma_f32_16x16x32_bf16 v[128:131], a[192:195], v[112:115], v[128:131]
  v_cvt_pk_bf16_f32 v116, v104, v105
  v_fma_f32 v108, v108, s40, v21
  v_mfma_f32_16x16x32_bf16 v[132:135], a[196:199], v[112:115], v[132:135]
  v_exp_f32 v108, v108
  v_mfma_f32_16x16x32_bf16 v[136:139], a[200:203], v[112:115], v[136:139]
  ds_read_b128 a[168:171], v4 offset:57344
  ds_read_b64_tr_b16 a[228:229], v7 offset:57344
  v_mfma_f32_16x16x32_bf16 v[140:143], a[204:207], v[112:115], v[140:143]
  v_cvt_pk_bf16_f32 v117, v106, v107
  v_fma_f32 v109, v109, s40, v21
  v_mfma_f32_16x16x32_bf16 v[144:147], a[208:211], v[112:115], v[144:147]
  ds_read_b64_tr_b16 a[230:231], v7 offset:61440
  ds_read_b128 a[184:187], v4 offset:61440
  v_mfma_f32_16x16x32_bf16 v[148:151], a[212:215], v[112:115], v[148:151]
  v_exp_f32 v109, v109
  v_mfma_f32_16x16x32_bf16 v[152:155], a[216:219], v[112:115], v[152:155]
  v_fma_f32 v110, v110, s40, v21
  v_fma_f32 v111, v111, s40, v21
  v_mfma_f32_16x16x32_bf16 v[156:159], a[220:223], v[112:115], v[156:159]
  ds_read_b64_tr_b16 a[232:233], v8 offset:57344
  v_exp_f32 v110, v110
  v_exp_f32 v111, v111
  v_mfma_f32_16x16x32_bf16 v[64:67], v[32:35], v[112:115], v[64:67]
  v_cvt_pk_bf16_f32 v118, v108, v109
  v_cvt_pk_bf16_f32 v119, v110, v111
  v_mfma_f32_16x16x32_bf16 v[104:107], a[128:131], a[48:51], 0
  ds_read_b64_tr_b16 a[234:235], v8 offset:61440
  v_fma_f32 v96, v96, s40, v22
  v_mfma_f32_16x16x32_bf16 v[104:107], a[132:135], a[52:55], v[104:107]
  ds_read_b128 a[172:175], v5 offset:57344
  v_fma_f32 v97, v97, s40, v22
  v_mfma_f32_16x16x32_bf16 v[104:107], a[136:139], a[56:59], v[104:107]
  ds_read_b64_tr_b16 a[236:237], v9 offset:57344
  ds_read_b64_tr_b16 a[238:239], v9 offset:61440
  v_mfma_f32_16x16x32_bf16 v[104:107], a[140:143], a[60:63], v[104:107]
  v_exp_f32 v96, v96
  v_mfma_f32_16x16x32_bf16 v[108:111], a[156:159], a[60:63], 0
  v_exp_f32 v97, v97
  v_mfma_f32_16x16x32_bf16 v[108:111], a[152:155], a[56:59], v[108:111]
  v_fma_f32 v98, v98, s40, v22
  v_fma_f32 v99, v99, s40, v22
  v_mfma_f32_16x16x32_bf16 v[108:111], a[148:151], a[52:55], v[108:111]
  v_exp_f32 v98, v98
  v_mfma_f32_16x16x32_bf16 v[108:111], a[144:147], a[48:51], v[108:111]
  v_exp_f32 v99, v99
  v_mfma_f32_16x16x32_bf16 v[160:163], a[192:195], v[116:119], v[160:163]
  ds_read_b128 a[188:191], v5 offset:61440
  ds_read_b64_tr_b16 a[240:241], v10 offset:57344
  v_mfma_f32_16x16x32_bf16 v[164:167], a[196:199], v[116:119], v[164:167]
  v_cvt_pk_bf16_f32 v112, v96, v97
  v_fma_f32 v100, v100, s40, v22
  v_mfma_f32_16x16x32_bf16 v[168:171], a[200:203], v[116:119], v[168:171]
  ds_read_b64_tr_b16 a[242:243], v10 offset:61440
  ds_read_b64_tr_b16 a[244:245], v11 offset:57344
  v_mfma_f32_16x16x32_bf16 v[172:175], a[204:207], v[116:119], v[172:175]
  v_exp_f32 v100, v100
  v_mfma_f32_16x16x32_bf16 v[176:179], a[208:211], v[116:119], v[176:179]
  v_cvt_pk_bf16_f32 v113, v98, v99
  v_fma_f32 v101, v101, s40, v22
  v_mfma_f32_16x16x32_bf16 v[180:183], a[212:215], v[116:119], v[180:183]
  v_exp_f32 v101, v101
  v_mfma_f32_16x16x32_bf16 v[184:187], a[216:219], v[116:119], v[184:187]
  v_fma_f32 v102, v102, s40, v22
  v_fma_f32 v103, v103, s40, v22
  v_mfma_f32_16x16x32_bf16 v[188:191], a[220:223], v[116:119], v[188:191]
  ds_read_b64_tr_b16 a[246:247], v11 offset:61440
  v_exp_f32 v102, v102
  v_exp_f32 v103, v103
  v_mfma_f32_16x16x32_bf16 v[68:71], v[32:35], v[116:119], v[68:71]
  v_cvt_pk_bf16_f32 v114, v100, v101
  v_cvt_pk_bf16_f32 v115, v102, v103
  s_waitcnt lgkmcnt(4)
  v_mfma_f32_16x16x32_bf16 v[96:99], a[160:163], a[0:3], 0
  ds_read_b64_tr_b16 a[248:249], v12 offset:57344
  v_fma_f32 v104, v104, s40, v23
  v_mfma_f32_16x16x32_bf16 v[96:99], a[164:167], a[4:7], v[96:99]
  ds_read_b64_tr_b16 a[250:251], v12 offset:61440
  v_fma_f32 v105, v105, s40, v23
  v_mfma_f32_16x16x32_bf16 v[96:99], a[168:171], a[8:11], v[96:99]
  v_exp_f32 v104, v104
  v_mfma_f32_16x16x32_bf16 v[96:99], a[172:175], a[12:15], v[96:99]
  v_exp_f32 v105, v105
  v_mfma_f32_16x16x32_bf16 v[100:103], a[188:191], a[12:15], 0
  v_fma_f32 v106, v106, s40, v23
  v_fma_f32 v107, v107, s40, v23
  v_mfma_f32_16x16x32_bf16 v[100:103], a[184:187], a[8:11], v[100:103]
  ds_read_b64_tr_b16 a[252:253], v13 offset:57344
  ds_read_b64_tr_b16 a[254:255], v13 offset:61440
  v_mfma_f32_16x16x32_bf16 v[100:103], a[180:183], a[4:7], v[100:103]
  v_exp_f32 v106, v106
  v_mfma_f32_16x16x32_bf16 v[100:103], a[176:179], a[0:3], v[100:103]
  v_exp_f32 v107, v107
  v_mfma_f32_16x16x32_bf16 v[192:195], a[192:195], v[112:115], v[192:195]
  v_cvt_pk_bf16_f32 v116, v104, v105
  v_fma_f32 v108, v108, s40, v23
  v_mfma_f32_16x16x32_bf16 v[196:199], a[196:199], v[112:115], v[196:199]
  v_exp_f32 v108, v108
  v_mfma_f32_16x16x32_bf16 v[200:203], a[200:203], v[112:115], v[200:203]
  v_cvt_pk_bf16_f32 v117, v106, v107
  v_fma_f32 v109, v109, s40, v23
  v_mfma_f32_16x16x32_bf16 v[204:207], a[204:207], v[112:115], v[204:207]
  v_exp_f32 v109, v109
  v_mfma_f32_16x16x32_bf16 v[208:211], a[208:211], v[112:115], v[208:211]
  v_fma_f32 v110, v110, s40, v23
  v_fma_f32 v111, v111, s40, v23
  v_mfma_f32_16x16x32_bf16 v[212:215], a[212:215], v[112:115], v[212:215]
  s_add_u32 m0, s80, 1920
  v_fma_f32 v96, v96, s40, v20
  v_mfma_f32_16x16x32_bf16 v[216:219], a[216:219], v[112:115], v[216:219]
  v_exp_f32 v110, v110
  v_mfma_f32_16x16x32_bf16 v[220:223], a[220:223], v[112:115], v[220:223]
  v_exp_f32 v111, v111
  v_mfma_f32_16x16x32_bf16 v[72:75], v[32:35], v[112:115], v[72:75]
  buffer_load_dwordx4 v48, s[16:19], s67 offen offset:128 nt lds
  buffer_load_dwordx4 v49, s[16:19], s67 offen offset:1152 nt lds
  v_cvt_pk_bf16_f32 v118, v108, v109
  v_cvt_pk_bf16_f32 v119, v110, v111
  v_mfma_f32_16x16x32_bf16 v[104:107], a[160:163], a[16:19], 0
  ds_read_b128 a[128:131], v2 offset:0
  v_fma_f32 v97, v97, s40, v20
  v_mfma_f32_16x16x32_bf16 v[104:107], a[164:167], a[20:23], v[104:107]
  v_exp_f32 v96, v96
  v_mfma_f32_16x16x32_bf16 v[104:107], a[168:171], a[24:27], v[104:107]
  v_exp_f32 v97, v97
  v_mfma_f32_16x16x32_bf16 v[104:107], a[172:175], a[28:31], v[104:107]
  v_fma_f32 v98, v98, s40, v20
  v_fma_f32 v99, v99, s40, v20
  v_mfma_f32_16x16x32_bf16 v[108:111], a[188:191], a[28:31], 0
  v_exp_f32 v98, v98
  v_mfma_f32_16x16x32_bf16 v[108:111], a[184:187], a[24:27], v[108:111]
  v_exp_f32 v99, v99
  v_mfma_f32_16x16x32_bf16 v[108:111], a[180:183], a[20:23], v[108:111]
  v_cvt_pk_bf16_f32 v112, v96, v97
  v_fma_f32 v100, v100, s40, v20
  v_mfma_f32_16x16x32_bf16 v[108:111], a[176:179], a[16:19], v[108:111]
  v_exp_f32 v100, v100
  v_mfma_f32_16x16x32_bf16 v[224:227], a[192:195], v[116:119], v[224:227]
  v_cvt_pk_bf16_f32 v113, v98, v99
  v_fma_f32 v101, v101, s40, v20
  v_mfma_f32_16x16x32_bf16 v[228:231], a[196:199], v[116:119], v[228:231]
  v_exp_f32 v101, v101
  v_mfma_f32_16x16x32_bf16 v[232:235], a[200:203], v[116:119], v[232:235]
  ds_read_b128 a[144:147], v2 offset:4096
  v_fma_f32 v102, v102, s40, v20
  v_mfma_f32_16x16x32_bf16 v[236:239], a[204:207], v[116:119], v[236:239]
  s_add_u32 s45, s45, 8192
  v_fma_f32 v103, v103, s40, v20
  v_mfma_f32_16x16x32_bf16 v[240:243], a[208:211], v[116:119], v[240:243]
  v_exp_f32 v102, v102
  v_mfma_f32_16x16x32_bf16 v[244:247], a[212:215], v[116:119], v[244:247]
  v_exp_f32 v103, v103
  v_mfma_f32_16x16x32_bf16 v[248:251], a[216:219], v[116:119], v[248:251]
  s_add_u32 m0, s44, 49152
  v_cvt_pk_bf16_f32 v114, v100, v101
  v_mfma_f32_16x16x32_bf16 v[252:255], a[220:223], v[116:119], v[252:255]
  ds_read_b128 a[132:135], v3 offset:0
  v_cvt_pk_bf16_f32 v115, v102, v103
  v_mfma_f32_16x16x32_bf16 v[76:79], v[32:35], v[116:119], v[76:79]
  v_fma_f32 v104, v104, s40, v21
  v_fma_f32 v105, v105, s40, v21
  v_mfma_f32_16x16x32_bf16 v[96:99], a[160:163], a[32:35], 0
  buffer_load_dwordx4 v14, s[20:23], s45 offen offset:0 lds
  buffer_load_dwordx4 v15, s[20:23], s45 offen offset:1024 lds
  buffer_load_dwordx4 v16, s[20:23], s45 offen offset:2048 lds
  buffer_load_dwordx4 v17, s[20:23], s45 offen offset:3072 lds
  v_mfma_f32_16x16x32_bf16 v[96:99], a[164:167], a[36:39], v[96:99]
  v_exp_f32 v104, v104
  v_mfma_f32_16x16x32_bf16 v[96:99], a[168:171], a[40:43], v[96:99]
  v_exp_f32 v105, v105
  v_mfma_f32_16x16x32_bf16 v[96:99], a[172:175], a[44:47], v[96:99]
  ds_read_b128 a[148:151], v3 offset:4096
  ds_read_b64_tr_b16 a[192:193], v6 offset:0
  v_mfma_f32_16x16x32_bf16 v[100:103], a[188:191], a[44:47], 0
  v_fma_f32 v106, v106, s40, v21
  v_fma_f32 v107, v107, s40, v21
  v_mfma_f32_16x16x32_bf16 v[100:103], a[184:187], a[40:43], v[100:103]
  v_exp_f32 v106, v106
  v_mfma_f32_16x16x32_bf16 v[100:103], a[180:183], a[36:39], v[100:103]
  ds_read_b64_tr_b16 a[194:195], v6 offset:4096
  ds_read_b128 a[136:139], v4 offset:0
  v_mfma_f32_16x16x32_bf16 v[100:103], a[176:179], a[32:35], v[100:103]
  ds_read_b64_tr_b16 a[196:197], v7 offset:0
  s_waitcnt lgkmcnt(8)
  v_mfma_f32_16x16x32_bf16 v[128:131], a[224:227], v[112:115], v[128:131]
  v_exp_f32 v107, v107
  v_mfma_f32_16x16x32_bf16 v[132:135], a[228:231], v[112:115], v[132:135]
  v_cvt_pk_bf16_f32 v116, v104, v105
  v_fma_f32 v108, v108, s40, v21
  v_mfma_f32_16x16x32_bf16 v[136:139], a[232:235], v[112:115], v[136:139]
  v_exp_f32 v108, v108
  v_mfma_f32_16x16x32_bf16 v[140:143], a[236:239], v[112:115], v[140:143]
  v_cvt_pk_bf16_f32 v117, v106, v107
  v_fma_f32 v109, v109, s40, v21
  v_mfma_f32_16x16x32_bf16 v[144:147], a[240:243], v[112:115], v[144:147]
  ds_read_b64_tr_b16 a[198:199], v7 offset:4096
  ds_read_b128 a[152:155], v4 offset:4096
  v_mfma_f32_16x16x32_bf16 v[148:151], a[244:247], v[112:115], v[148:151]
  v_exp_f32 v109, v109
  v_mfma_f32_16x16x32_bf16 v[152:155], a[248:251], v[112:115], v[152:155]
  v_fma_f32 v110, v110, s40, v21
  v_fma_f32 v111, v111, s40, v21
  v_mfma_f32_16x16x32_bf16 v[156:159], a[252:255], v[112:115], v[156:159]
  ds_read_b64_tr_b16 a[200:201], v8 offset:0
  v_exp_f32 v110, v110
  v_exp_f32 v111, v111
  v_mfma_f32_16x16x32_bf16 v[64:67], v[32:35], v[112:115], v[64:67]
  v_cvt_pk_bf16_f32 v118, v108, v109
  v_cvt_pk_bf16_f32 v119, v110, v111
  v_mfma_f32_16x16x32_bf16 v[104:107], a[160:163], a[48:51], 0
  ds_read_b64_tr_b16 a[202:203], v8 offset:4096
  v_fma_f32 v96, v96, s40, v22
  v_mfma_f32_16x16x32_bf16 v[104:107], a[164:167], a[52:55], v[104:107]
  ds_read_b128 a[140:143], v5 offset:0
  v_fma_f32 v97, v97, s40, v22
  v_mfma_f32_16x16x32_bf16 v[104:107], a[168:171], a[56:59], v[104:107]
  ds_read_b64_tr_b16 a[204:205], v9 offset:0
  ds_read_b64_tr_b16 a[206:207], v9 offset:4096
  v_mfma_f32_16x16x32_bf16 v[104:107], a[172:175], a[60:63], v[104:107]
  v_exp_f32 v96, v96
  v_mfma_f32_16x16x32_bf16 v[108:111], a[188:191], a[60:63], 0
  v_exp_f32 v97, v97
  v_mfma_f32_16x16x32_bf16 v[108:111], a[184:187], a[56:59], v[108:111]
  v_fma_f32 v98, v98, s40, v22
  v_fma_f32 v99, v99, s40, v22
  v_mfma_f32_16x16x32_bf16 v[108:111], a[180:183], a[52:55], v[108:111]
  v_exp_f32 v98, v98
  v_mfma_f32_16x16x32_bf16 v[108:111], a[176:179], a[48:51], v[108:111]
  v_exp_f32 v99, v99
  v_mfma_f32_16x16x32_bf16 v[160:163], a[224:227], v[116:119], v[160:163]
  ds_read_b128 a[156:159], v5 offset:4096
  ds_read_b64_tr_b16 a[208:209], v10 offset:0
  v_mfma_f32_16x16x32_bf16 v[164:167], a[228:231], v[116:119], v[164:167]
  v_cvt_pk_bf16_f32 v112, v96, v97
  v_fma_f32 v100, v100, s40, v22
  v_mfma_f32_16x16x32_bf16 v[168:171], a[232:235], v[116:119], v[168:171]
  ds_read_b64_tr_b16 a[210:211], v10 offset:4096
  ds_read_b64_tr_b16 a[212:213], v11 offset:0
  v_mfma_f32_16x16x32_bf16 v[172:175], a[236:239], v[116:119], v[172:175]
  v_exp_f32 v100, v100
  v_mfma_f32_16x16x32_bf16 v[176:179], a[240:243], v[116:119], v[176:179]
  v_cvt_pk_bf16_f32 v113, v98, v99
  v_fma_f32 v101, v101, s40, v22
  v_mfma_f32_16x16x32_bf16 v[180:183], a[244:247], v[116:119], v[180:183]
  v_exp_f32 v101, v101
  v_mfma_f32_16x16x32_bf16 v[184:187], a[248:251], v[116:119], v[184:187]
  v_fma_f32 v102, v102, s40, v22
  v_fma_f32 v103, v103, s40, v22
  v_mfma_f32_16x16x32_bf16 v[188:191], a[252:255], v[116:119], v[188:191]
  ds_read_b64_tr_b16 a[214:215], v11 offset:4096
  v_exp_f32 v102, v102
  v_exp_f32 v103, v103
  v_mfma_f32_16x16x32_bf16 v[68:71], v[32:35], v[116:119], v[68:71]
  v_cvt_pk_bf16_f32 v114, v100, v101
  v_cvt_pk_bf16_f32 v115, v102, v103
  s_waitcnt lgkmcnt(4)
  v_mfma_f32_16x16x32_bf16 v[96:99], a[128:131], a[0:3], 0
  ds_read_b64_tr_b16 a[216:217], v12 offset:0
  v_fma_f32 v104, v104, s40, v23
  v_mfma_f32_16x16x32_bf16 v[96:99], a[132:135], a[4:7], v[96:99]
  ds_read_b64_tr_b16 a[218:219], v12 offset:4096
  v_fma_f32 v105, v105, s40, v23
  v_mfma_f32_16x16x32_bf16 v[96:99], a[136:139], a[8:11], v[96:99]
  v_exp_f32 v104, v104
  v_mfma_f32_16x16x32_bf16 v[96:99], a[140:143], a[12:15], v[96:99]
  v_exp_f32 v105, v105
  v_mfma_f32_16x16x32_bf16 v[100:103], a[156:159], a[12:15], 0
  v_fma_f32 v106, v106, s40, v23
  v_fma_f32 v107, v107, s40, v23
  v_mfma_f32_16x16x32_bf16 v[100:103], a[152:155], a[8:11], v[100:103]
  ds_read_b64_tr_b16 a[220:221], v13 offset:0
  ds_read_b64_tr_b16 a[222:223], v13 offset:4096
  v_mfma_f32_16x16x32_bf16 v[100:103], a[148:151], a[4:7], v[100:103]
  v_exp_f32 v106, v106
  v_mfma_f32_16x16x32_bf16 v[100:103], a[144:147], a[0:3], v[100:103]
  v_exp_f32 v107, v107
  v_mfma_f32_16x16x32_bf16 v[192:195], a[224:227], v[112:115], v[192:195]
  v_cvt_pk_bf16_f32 v116, v104, v105
  v_fma_f32 v108, v108, s40, v23
  v_mfma_f32_16x16x32_bf16 v[196:199], a[228:231], v[112:115], v[196:199]
  v_exp_f32 v108, v108
  v_mfma_f32_16x16x32_bf16 v[200:203], a[232:235], v[112:115], v[200:203]
  v_cvt_pk_bf16_f32 v117, v106, v107
  v_fma_f32 v109, v109, s40, v23
  v_mfma_f32_16x16x32_bf16 v[204:207], a[236:239], v[112:115], v[204:207]
  v_exp_f32 v109, v109
  v_mfma_f32_16x16x32_bf16 v[208:211], a[240:243], v[112:115], v[208:211]
  s_add_u32 s67, s67, 4096
  v_fma_f32 v110, v110, s40, v23
  v_mfma_f32_16x16x32_bf16 v[212:215], a[244:247], v[112:115], v[212:215]
  s_add_u32 m0, s80, 4096
  v_fma_f32 v111, v111, s40, v23
  v_mfma_f32_16x16x32_bf16 v[216:219], a[248:251], v[112:115], v[216:219]
  v_exp_f32 v110, v110
  v_mfma_f32_16x16x32_bf16 v[220:223], a[252:255], v[112:115], v[220:223]
  v_exp_f32 v111, v111
  v_mfma_f32_16x16x32_bf16 v[72:75], v[32:35], v[112:115], v[72:75]
  buffer_load_dwordx4 v48, s[16:19], s67 offen offset:0 nt lds
  buffer_load_dwordx4 v49, s[16:19], s67 offen offset:1024 nt lds
  v_cvt_pk_bf16_f32 v118, v108, v109
  v_cvt_pk_bf16_f32 v119, v110, v111
  s_waitcnt vmcnt(26) lgkmcnt(0)
  s_barrier
  v_mfma_f32_16x16x32_bf16 v[104:107], a[128:131], a[16:19], 0
  v_fma_f32 v96, v96, s40, v20
  v_fma_f32 v97, v97, s40, v20
  v_mfma_f32_16x16x32_bf16 v[104:107], a[132:135], a[20:23], v[104:107]
  v_exp_f32 v96, v96
  v_mfma_f32_16x16x32_bf16 v[104:107], a[136:139], a[24:27], v[104:107]
  v_exp_f32 v97, v97
  v_mfma_f32_16x16x32_bf16 v[104:107], a[140:143], a[28:31], v[104:107]
  v_fma_f32 v98, v98, s40, v20
  v_fma_f32 v99, v99, s40, v20
  v_mfma_f32_16x16x32_bf16 v[108:111], a[156:159], a[28:31], 0
  v_exp_f32 v98, v98
  v_mfma_f32_16x16x32_bf16 v[108:111], a[152:155], a[24:27], v[108:111]
  ds_read_b128 a[160:163], v2 offset:8192
  ds_read_b128 a[176:179], v2 offset:12288
  v_mfma_f32_16x16x32_bf16 v[108:111], a[148:151], a[20:23], v[108:111]
  v_exp_f32 v99, v99
  v_mfma_f32_16x16x32_bf16 v[108:111], a[144:147], a[16:19], v[108:111]
  v_cvt_pk_bf16_f32 v112, v96, v97
  v_fma_f32 v100, v100, s40, v20
  v_mfma_f32_16x16x32_bf16 v[224:227], a[224:227], v[116:119], v[224:227]
  v_exp_f32 v100, v100
  v_mfma_f32_16x16x32_bf16 v[228:231], a[228:231], v[116:119], v[228:231]
  v_cvt_pk_bf16_f32 v113, v98, v99
  v_fma_f32 v101, v101, s40, v20
  v_mfma_f32_16x16x32_bf16 v[232:235], a[232:235], v[116:119], v[232:235]
  v_exp_f32 v101, v101
  v_mfma_f32_16x16x32_bf16 v[236:239], a[236:239], v[116:119], v[236:239]
  v_fma_f32 v102, v102, s40, v20
  v_fma_f32 v103, v103, s40, v20
  v_mfma_f32_16x16x32_bf16 v[240:243], a[240:243], v[116:119], v[240:243]
  v_exp_f32 v102, v102
  v_mfma_f32_16x16x32_bf16 v[244:247], a[244:247], v[116:119], v[244:247]
  v_exp_f32 v103, v103
  v_mfma_f32_16x16x32_bf16 v[248:251], a[248:251], v[116:119], v[248:251]
  s_add_u32 s45, s45, 8192
  s_add_u32 m0, s44, 57344
  v_mfma_f32_16x16x32_bf16 v[252:255], a[252:255], v[116:119], v[252:255]
  v_cvt_pk_bf16_f32 v114, v100, v101
  v_cvt_pk_bf16_f32 v115, v102, v103
  v_mfma_f32_16x16x32_bf16 v[76:79], v[32:35], v[116:119], v[76:79]
  ds_read_b128 a[164:167], v3 offset:8192
  v_fma_f32 v104, v104, s40, v21
  v_mfma_f32_16x16x32_bf16 v[96:99], a[128:131], a[32:35], 0
  buffer_load_dwordx4 v14, s[20:23], s45 offen offset:0 lds
  buffer_load_dwordx4 v15, s[20:23], s45 offen offset:1024 lds
  buffer_load_dwordx4 v16, s[20:23], s45 offen offset:2048 lds
  buffer_load_dwordx4 v17, s[20:23], s45 offen offset:3072 lds
  v_mfma_f32_16x16x32_bf16 v[96:99], a[132:135], a[36:39], v[96:99]
  ds_read_b128 a[180:183], v3 offset:12288
  v_fma_f32 v105, v105, s40, v21
  v_mfma_f32_16x16x32_bf16 v[96:99], a[136:139], a[40:43], v[96:99]
  v_exp_f32 v104, v104
  v_mfma_f32_16x16x32_bf16 v[96:99], a[140:143], a[44:47], v[96:99]
  v_exp_f32 v105, v105
  v_mfma_f32_16x16x32_bf16 v[100:103], a[156:159], a[44:47], 0
  ds_read_b64_tr_b16 a[224:225], v6 offset:8192
  v_fma_f32 v106, v106, s40, v21
  v_mfma_f32_16x16x32_bf16 v[100:103], a[152:155], a[40:43], v[100:103]
  ds_read_b64_tr_b16 a[226:227], v6 offset:12288
  v_fma_f32 v107, v107, s40, v21
  v_mfma_f32_16x16x32_bf16 v[100:103], a[148:151], a[36:39], v[100:103]
  v_exp_f32 v106, v106
  v_mfma_f32_16x16x32_bf16 v[100:103], a[144:147], a[32:35], v[100:103]
  v_exp_f32 v107, v107
  v_mfma_f32_16x16x32_bf16 v[128:131], a[192:195], v[112:115], v[128:131]
  v_cvt_pk_bf16_f32 v116, v104, v105
  v_fma_f32 v108, v108, s40, v21
  v_mfma_f32_16x16x32_bf16 v[132:135], a[196:199], v[112:115], v[132:135]
  v_exp_f32 v108, v108
  v_mfma_f32_16x16x32_bf16 v[136:139], a[200:203], v[112:115], v[136:139]
  ds_read_b128 a[168:171], v4 offset:8192
  ds_read_b64_tr_b16 a[228:229], v7 offset:8192
  v_mfma_f32_16x16x32_bf16 v[140:143], a[204:207], v[112:115], v[140:143]
  v_cvt_pk_bf16_f32 v117, v106, v107
  v_fma_f32 v109, v109, s40, v21
  v_mfma_f32_16x16x32_bf16 v[144:147], a[208:211], v[112:115], v[144:147]
  ds_read_b64_tr_b16 a[230:231], v7 offset:12288
  ds_read_b128 a[184:187], v4 offset:12288
  v_mfma_f32_16x16x32_bf16 v[148:151], a[212:215], v[112:115], v[148:151]
  v_exp_f32 v109, v109
  v_mfma_f32_16x16x32_bf16 v[152:155], a[216:219], v[112:115], v[152:155]
  v_fma_f32 v110, v110, s40, v21
  v_fma_f32 v111, v111, s40, v21
  v_mfma_f32_16x16x32_bf16 v[156:159], a[220:223], v[112:115], v[156:159]
  ds_read_b64_tr_b16 a[232:233], v8 offset:8192
  v_exp_f32 v110, v110
  v_exp_f32 v111, v111
  v_mfma_f32_16x16x32_bf16 v[64:67], v[32:35], v[112:115], v[64:67]
  v_cvt_pk_bf16_f32 v118, v108, v109
  v_cvt_pk_bf16_f32 v119, v110, v111
  v_mfma_f32_16x16x32_bf16 v[104:107], a[128:131], a[48:51], 0
  ds_read_b64_tr_b16 a[234:235], v8 offset:12288
  v_fma_f32 v96, v96, s40, v22
  v_mfma_f32_16x16x32_bf16 v[104:107], a[132:135], a[52:55], v[104:107]
  ds_read_b128 a[172:175], v5 offset:8192
  v_fma_f32 v97, v97, s40, v22
  v_mfma_f32_16x16x32_bf16 v[104:107], a[136:139], a[56:59], v[104:107]
  ds_read_b64_tr_b16 a[236:237], v9 offset:8192
  ds_read_b64_tr_b16 a[238:239], v9 offset:12288
  v_mfma_f32_16x16x32_bf16 v[104:107], a[140:143], a[60:63], v[104:107]
  v_exp_f32 v96, v96
  v_mfma_f32_16x16x32_bf16 v[108:111], a[156:159], a[60:63], 0
  v_exp_f32 v97, v97
  v_mfma_f32_16x16x32_bf16 v[108:111], a[152:155], a[56:59], v[108:111]
  v_fma_f32 v98, v98, s40, v22
  v_fma_f32 v99, v99, s40, v22
  v_mfma_f32_16x16x32_bf16 v[108:111], a[148:151], a[52:55], v[108:111]
  v_exp_f32 v98, v98
  v_mfma_f32_16x16x32_bf16 v[108:111], a[144:147], a[48:51], v[108:111]
  v_exp_f32 v99, v99
  v_mfma_f32_16x16x32_bf16 v[160:163], a[192:195], v[116:119], v[160:163]
  ds_read_b128 a[188:191], v5 offset:12288
  ds_read_b64_tr_b16 a[240:241], v10 offset:8192
  v_mfma_f32_16x16x32_bf16 v[164:167], a[196:199], v[116:119], v[164:167]
  v_cvt_pk_bf16_f32 v112, v96, v97
  v_fma_f32 v100, v100, s40, v22
  v_mfma_f32_16x16x32_bf16 v[168:171], a[200:203], v[116:119], v[168:171]
  ds_read_b64_tr_b16 a[242:243], v10 offset:12288
  ds_read_b64_tr_b16 a[244:245], v11 offset:8192
  v_mfma_f32_16x16x32_bf16 v[172:175], a[204:207], v[116:119], v[172:175]
  v_exp_f32 v100, v100
  v_mfma_f32_16x16x32_bf16 v[176:179], a[208:211], v[116:119], v[176:179]
  v_cvt_pk_bf16_f32 v113, v98, v99
  v_fma_f32 v101, v101, s40, v22
  v_mfma_f32_16x16x32_bf16 v[180:183], a[212:215], v[116:119], v[180:183]
  v_exp_f32 v101, v101
  v_mfma_f32_16x16x32_bf16 v[184:187], a[216:219], v[116:119], v[184:187]
  v_fma_f32 v102, v102, s40, v22
  v_fma_f32 v103, v103, s40, v22
  v_mfma_f32_16x16x32_bf16 v[188:191], a[220:223], v[116:119], v[188:191]
  s_waitcnt vmcnt(16)
  ds_read_b128 a[64:67], v52 offset:0
  ds_read_b128 a[68:71], v53 offset:0
  ds_read_b64_tr_b16 a[246:247], v11 offset:12288
  v_exp_f32 v102, v102
  v_exp_f32 v103, v103
  v_mfma_f32_16x16x32_bf16 v[68:71], v[32:35], v[116:119], v[68:71]
  v_cvt_pk_bf16_f32 v114, v100, v101
  v_cvt_pk_bf16_f32 v115, v102, v103
  s_waitcnt lgkmcnt(6)
  v_mfma_f32_16x16x32_bf16 v[96:99], a[160:163], a[0:3], 0
  ds_read_b64_tr_b16 a[248:249], v12 offset:8192
  v_fma_f32 v104, v104, s40, v23
  v_mfma_f32_16x16x32_bf16 v[96:99], a[164:167], a[4:7], v[96:99]
  ds_read_b64_tr_b16 a[250:251], v12 offset:12288
  v_fma_f32 v105, v105, s40, v23
  v_mfma_f32_16x16x32_bf16 v[96:99], a[168:171], a[8:11], v[96:99]
  v_exp_f32 v104, v104
  v_mfma_f32_16x16x32_bf16 v[96:99], a[172:175], a[12:15], v[96:99]
  v_exp_f32 v105, v105
  v_mfma_f32_16x16x32_bf16 v[100:103], a[188:191], a[12:15], 0
  v_fma_f32 v106, v106, s40, v23
  v_fma_f32 v107, v107, s40, v23
  v_mfma_f32_16x16x32_bf16 v[100:103], a[184:187], a[8:11], v[100:103]
  ds_read_b64_tr_b16 a[252:253], v13 offset:8192
  ds_read_b64_tr_b16 a[254:255], v13 offset:12288
  v_mfma_f32_16x16x32_bf16 v[100:103], a[180:183], a[4:7], v[100:103]
  v_exp_f32 v106, v106
  v_mfma_f32_16x16x32_bf16 v[100:103], a[176:179], a[0:3], v[100:103]
  v_exp_f32 v107, v107
  v_mfma_f32_16x16x32_bf16 v[192:195], a[192:195], v[112:115], v[192:195]
  v_cvt_pk_bf16_f32 v116, v104, v105
  v_fma_f32 v108, v108, s40, v23
  v_mfma_f32_16x16x32_bf16 v[196:199], a[196:199], v[112:115], v[196:199]
  v_exp_f32 v108, v108
  v_mfma_f32_16x16x32_bf16 v[200:203], a[200:203], v[112:115], v[200:203]
  v_cvt_pk_bf16_f32 v117, v106, v107
  v_fma_f32 v109, v109, s40, v23
  v_mfma_f32_16x16x32_bf16 v[204:207], a[204:207], v[112:115], v[204:207]
  v_exp_f32 v109, v109
  v_mfma_f32_16x16x32_bf16 v[208:211], a[208:211], v[112:115], v[208:211]
  v_fma_f32 v110, v110, s40, v23
  v_fma_f32 v111, v111, s40, v23
  v_mfma_f32_16x16x32_bf16 v[212:215], a[212:215], v[112:115], v[212:215]
  s_add_u32 m0, s80, 6016
  v_fma_f32 v96, v96, s40, v20
  v_mfma_f32_16x16x32_bf16 v[216:219], a[216:219], v[112:115], v[216:219]
  v_exp_f32 v110, v110
  v_mfma_f32_16x16x32_bf16 v[220:223], a[220:223], v[112:115], v[220:223]
  v_exp_f32 v111, v111
  v_mfma_f32_16x16x32_bf16 v[72:75], v[32:35], v[112:115], v[72:75]
  buffer_load_dwordx4 v48, s[16:19], s67 offen offset:128 nt lds
  buffer_load_dwordx4 v49, s[16:19], s67 offen offset:1152 nt lds
  v_cvt_pk_bf16_f32 v118, v108, v109
  v_cvt_pk_bf16_f32 v119, v110, v111
  v_mfma_f32_16x16x32_bf16 v[104:107], a[160:163], a[16:19], 0
  ds_read_b128 a[128:131], v2 offset:16384
  v_fma_f32 v97, v97, s40, v20
  v_mfma_f32_16x16x32_bf16 v[104:107], a[164:167], a[20:23], v[104:107]
  v_exp_f32 v96, v96
  v_mfma_f32_16x16x32_bf16 v[104:107], a[168:171], a[24:27], v[104:107]
  v_exp_f32 v97, v97
  v_mfma_f32_16x16x32_bf16 v[104:107], a[172:175], a[28:31], v[104:107]
  v_fma_f32 v98, v98, s40, v20
  v_fma_f32 v99, v99, s40, v20
  v_mfma_f32_16x16x32_bf16 v[108:111], a[188:191], a[28:31], 0
  v_exp_f32 v98, v98
  v_mfma_f32_16x16x32_bf16 v[108:111], a[184:187], a[24:27], v[108:111]
  v_exp_f32 v99, v99
  v_mfma_f32_16x16x32_bf16 v[108:111], a[180:183], a[20:23], v[108:111]
  v_cvt_pk_bf16_f32 v112, v96, v97
  v_fma_f32 v100, v100, s40, v20
  v_mfma_f32_16x16x32_bf16 v[108:111], a[176:179], a[16:19], v[108:111]
  v_exp_f32 v100, v100
  v_mfma_f32_16x16x32_bf16 v[224:227], a[192:195], v[116:119], v[224:227]
  v_cvt_pk_bf16_f32 v113, v98, v99
  v_fma_f32 v101, v101, s40, v20
  v_mfma_f32_16x16x32_bf16 v[228:231], a[196:199], v[116:119], v[228:231]
  v_exp_f32 v101, v101
  v_mfma_f32_16x16x32_bf16 v[232:235], a[200:203], v[116:119], v[232:235]
  ds_read_b128 a[144:147], v2 offset:20480
  v_fma_f32 v102, v102, s40, v20
  v_mfma_f32_16x16x32_bf16 v[236:239], a[204:207], v[116:119], v[236:239]
  s_add_u32 s45, s49, s64
  v_fma_f32 v103, v103, s40, v20
  v_mfma_f32_16x16x32_bf16 v[240:243], a[208:211], v[116:119], v[240:243]
  v_exp_f32 v102, v102
  v_mfma_f32_16x16x32_bf16 v[244:247], a[212:215], v[116:119], v[244:247]
  v_exp_f32 v103, v103
  v_mfma_f32_16x16x32_bf16 v[248:251], a[216:219], v[116:119], v[248:251]
  s_add_u32 m0, s44, 0
  v_cvt_pk_bf16_f32 v114, v100, v101
  v_mfma_f32_16x16x32_bf16 v[252:255], a[220:223], v[116:119], v[252:255]
  ds_read_b128 a[132:135], v3 offset:16384
  v_cvt_pk_bf16_f32 v115, v102, v103
  v_mfma_f32_16x16x32_bf16 v[76:79], v[32:35], v[116:119], v[76:79]
  v_fma_f32 v104, v104, s40, v21
  v_fma_f32 v105, v105, s40, v21
  v_mfma_f32_16x16x32_bf16 v[96:99], a[160:163], a[32:35], 0
  buffer_load_dwordx4 v14, s[20:23], s45 offen offset:0 lds
  buffer_load_dwordx4 v15, s[20:23], s45 offen offset:1024 lds
  buffer_load_dwordx4 v16, s[20:23], s45 offen offset:2048 lds
  buffer_load_dwordx4 v17, s[20:23], s45 offen offset:3072 lds
  v_mfma_f32_16x16x32_bf16 v[96:99], a[164:167], a[36:39], v[96:99]
  v_exp_f32 v104, v104
  v_mfma_f32_16x16x32_bf16 v[96:99], a[168:171], a[40:43], v[96:99]
  v_exp_f32 v105, v105
  v_mfma_f32_16x16x32_bf16 v[96:99], a[172:175], a[44:47], v[96:99]
  ds_read_b128 a[148:151], v3 offset:20480
  ds_read_b64_tr_b16 a[192:193], v6 offset:16384
  v_mfma_f32_16x16x32_bf16 v[100:103], a[188:191], a[44:47], 0
  v_fma_f32 v106, v106, s40, v21
  v_fma_f32 v107, v107, s40, v21
  v_mfma_f32_16x16x32_bf16 v[100:103], a[184:187], a[40:43], v[100:103]
  v_exp_f32 v106, v106
  v_mfma_f32_16x16x32_bf16 v[100:103], a[180:183], a[36:39], v[100:103]
  ds_read_b64_tr_b16 a[194:195], v6 offset:20480
  ds_read_b128 a[136:139], v4 offset:16384
  v_mfma_f32_16x16x32_bf16 v[100:103], a[176:179], a[32:35], v[100:103]
  ds_read_b64_tr_b16 a[196:197], v7 offset:16384
  s_waitcnt lgkmcnt(8)
  v_mfma_f32_16x16x32_bf16 v[128:131], a[224:227], v[112:115], v[128:131]
  v_exp_f32 v107, v107
  v_mfma_f32_16x16x32_bf16 v[132:135], a[228:231], v[112:115], v[132:135]
  v_cvt_pk_bf16_f32 v116, v104, v105
  v_fma_f32 v108, v108, s40, v21
  v_mfma_f32_16x16x32_bf16 v[136:139], a[232:235], v[112:115], v[136:139]
  v_exp_f32 v108, v108
  v_mfma_f32_16x16x32_bf16 v[140:143], a[236:239], v[112:115], v[140:143]
  v_cvt_pk_bf16_f32 v117, v106, v107
  v_fma_f32 v109, v109, s40, v21
  v_mfma_f32_16x16x32_bf16 v[144:147], a[240:243], v[112:115], v[144:147]
  ds_read_b64_tr_b16 a[198:199], v7 offset:20480
  ds_read_b128 a[152:155], v4 offset:20480
  v_mfma_f32_16x16x32_bf16 v[148:151], a[244:247], v[112:115], v[148:151]
  v_exp_f32 v109, v109
  v_mfma_f32_16x16x32_bf16 v[152:155], a[248:251], v[112:115], v[152:155]
  v_fma_f32 v110, v110, s40, v21
  v_fma_f32 v111, v111, s40, v21
  v_mfma_f32_16x16x32_bf16 v[156:159], a[252:255], v[112:115], v[156:159]
  ds_read_b64_tr_b16 a[200:201], v8 offset:16384
  v_exp_f32 v110, v110
  v_exp_f32 v111, v111
  v_mfma_f32_16x16x32_bf16 v[64:67], v[32:35], v[112:115], v[64:67]
  v_cvt_pk_bf16_f32 v118, v108, v109
  v_cvt_pk_bf16_f32 v119, v110, v111
  v_mfma_f32_16x16x32_bf16 v[104:107], a[160:163], a[48:51], 0
  ds_read_b64_tr_b16 a[202:203], v8 offset:20480
  v_fma_f32 v96, v96, s40, v22
  v_mfma_f32_16x16x32_bf16 v[104:107], a[164:167], a[52:55], v[104:107]
  ds_read_b128 a[140:143], v5 offset:16384
  v_fma_f32 v97, v97, s40, v22
  v_mfma_f32_16x16x32_bf16 v[104:107], a[168:171], a[56:59], v[104:107]
  ds_read_b64_tr_b16 a[204:205], v9 offset:16384
  ds_read_b64_tr_b16 a[206:207], v9 offset:20480
  v_mfma_f32_16x16x32_bf16 v[104:107], a[172:175], a[60:63], v[104:107]
  v_exp_f32 v96, v96
  v_mfma_f32_16x16x32_bf16 v[108:111], a[188:191], a[60:63], 0
  v_exp_f32 v97, v97
  v_mfma_f32_16x16x32_bf16 v[108:111], a[184:187], a[56:59], v[108:111]
  v_fma_f32 v98, v98, s40, v22
  v_fma_f32 v99, v99, s40, v22
  v_mfma_f32_16x16x32_bf16 v[108:111], a[180:183], a[52:55], v[108:111]
  v_exp_f32 v98, v98
  v_mfma_f32_16x16x32_bf16 v[108:111], a[176:179], a[48:51], v[108:111]
  v_exp_f32 v99, v99
  v_mfma_f32_16x16x32_bf16 v[160:163], a[224:227], v[116:119], v[160:163]
  ds_read_b128 a[156:159], v5 offset:20480
  ds_read_b64_tr_b16 a[208:209], v10 offset:16384
  v_mfma_f32_16x16x32_bf16 v[164:167], a[228:231], v[116:119], v[164:167]
  v_cvt_pk_bf16_f32 v112, v96, v97
  v_fma_f32 v100, v100, s40, v22
  v_mfma_f32_16x16x32_bf16 v[168:171], a[232:235], v[116:119], v[168:171]
  ds_read_b64_tr_b16 a[210:211], v10 offset:20480
  ds_read_b64_tr_b16 a[212:213], v11 offset:16384
  v_mfma_f32_16x16x32_bf16 v[172:175], a[236:239], v[116:119], v[172:175]
  v_exp_f32 v100, v100
  v_mfma_f32_16x16x32_bf16 v[176:179], a[240:243], v[116:119], v[176:179]
  v_cvt_pk_bf16_f32 v113, v98, v99
  v_fma_f32 v101, v101, s40, v22
  v_mfma_f32_16x16x32_bf16 v[180:183], a[244:247], v[116:119], v[180:183]
  v_exp_f32 v101, v101
  v_mfma_f32_16x16x32_bf16 v[184:187], a[248:251], v[116:119], v[184:187]
  v_fma_f32 v102, v102, s40, v22
  v_fma_f32 v103, v103, s40, v22
  v_mfma_f32_16x16x32_bf16 v[188:191], a[252:255], v[116:119], v[188:191]
  s_waitcnt vmcnt(16)
  ds_read_b128 a[72:75], v52 offset:2048
  ds_read_b128 a[76:79], v53 offset:2048
  ds_read_b64_tr_b16 a[214:215], v11 offset:20480
  v_exp_f32 v102, v102
  v_exp_f32 v103, v103
  v_mfma_f32_16x16x32_bf16 v[68:71], v[32:35], v[116:119], v[68:71]
  v_cvt_pk_bf16_f32 v114, v100, v101
  v_cvt_pk_bf16_f32 v115, v102, v103
  s_waitcnt lgkmcnt(6)
  v_mfma_f32_16x16x32_bf16 v[96:99], a[128:131], a[0:3], 0
  ds_read_b64_tr_b16 a[216:217], v12 offset:16384
  v_fma_f32 v104, v104, s40, v23
  v_mfma_f32_16x16x32_bf16 v[96:99], a[132:135], a[4:7], v[96:99]
  ds_read_b64_tr_b16 a[218:219], v12 offset:20480
  v_fma_f32 v105, v105, s40, v23
  v_mfma_f32_16x16x32_bf16 v[96:99], a[136:139], a[8:11], v[96:99]
  v_exp_f32 v104, v104
  v_mfma_f32_16x16x32_bf16 v[96:99], a[140:143], a[12:15], v[96:99]
  v_exp_f32 v105, v105
  v_mfma_f32_16x16x32_bf16 v[100:103], a[156:159], a[12:15], 0
  v_fma_f32 v106, v106, s40, v23
  v_fma_f32 v107, v107, s40, v23
  v_mfma_f32_16x16x32_bf16 v[100:103], a[152:155], a[8:11], v[100:103]
  ds_read_b64_tr_b16 a[220:221], v13 offset:16384
  ds_read_b64_tr_b16 a[222:223], v13 offset:20480
  v_mfma_f32_16x16x32_bf16 v[100:103], a[148:151], a[4:7], v[100:103]
  v_exp_f32 v106, v106
  v_mfma_f32_16x16x32_bf16 v[100:103], a[144:147], a[0:3], v[100:103]
  v_exp_f32 v107, v107
  v_mfma_f32_16x16x32_bf16 v[192:195], a[224:227], v[112:115], v[192:195]
  v_cvt_pk_bf16_f32 v116, v104, v105
  v_fma_f32 v108, v108, s40, v23
  v_mfma_f32_16x16x32_bf16 v[196:199], a[228:231], v[112:115], v[196:199]
  v_exp_f32 v108, v108
  v_mfma_f32_16x16x32_bf16 v[200:203], a[232:235], v[112:115], v[200:203]
  v_cvt_pk_bf16_f32 v117, v106, v107
  v_fma_f32 v109, v109, s40, v23
  v_mfma_f32_16x16x32_bf16 v[204:207], a[236:239], v[112:115], v[204:207]
  v_exp_f32 v109, v109
  v_mfma_f32_16x16x32_bf16 v[208:211], a[240:243], v[112:115], v[208:211]
  s_add_u32 s67, s67, 4096
  v_fma_f32 v110, v110, s40, v23
  v_mfma_f32_16x16x32_bf16 v[212:215], a[244:247], v[112:115], v[212:215]
  s_add_u32 m0, s80, 0
  v_fma_f32 v111, v111, s40, v23
  v_mfma_f32_16x16x32_bf16 v[216:219], a[248:251], v[112:115], v[216:219]
  v_exp_f32 v110, v110
  v_mfma_f32_16x16x32_bf16 v[220:223], a[252:255], v[112:115], v[220:223]
  v_exp_f32 v111, v111
  v_mfma_f32_16x16x32_bf16 v[72:75], v[32:35], v[112:115], v[72:75]
  buffer_load_dwordx4 v48, s[16:19], s67 offen offset:0 nt lds
  buffer_load_dwordx4 v49, s[16:19], s67 offen offset:1024 nt lds
  v_cvt_pk_bf16_f32 v118, v108, v109
  v_cvt_pk_bf16_f32 v119, v110, v111
  s_waitcnt lgkmcnt(0)
  s_barrier
  v_mfma_f32_16x16x32_bf16 v[104:107], a[128:131], a[16:19], 0
  v_fma_f32 v96, v96, s40, v20
  v_fma_f32 v97, v97, s40, v20
  v_mfma_f32_16x16x32_bf16 v[104:107], a[132:135], a[20:23], v[104:107]
  v_exp_f32 v96, v96
  v_mfma_f32_16x16x32_bf16 v[104:107], a[136:139], a[24:27], v[104:107]
  v_exp_f32 v97, v97
  v_mfma_f32_16x16x32_bf16 v[104:107], a[140:143], a[28:31], v[104:107]
  v_fma_f32 v98, v98, s40, v20
  v_fma_f32 v99, v99, s40, v20
  v_mfma_f32_16x16x32_bf16 v[108:111], a[156:159], a[28:31], 0
  v_exp_f32 v98, v98
  v_mfma_f32_16x16x32_bf16 v[108:111], a[152:155], a[24:27], v[108:111]
  ds_read_b128 a[160:163], v2 offset:24576
  ds_read_b128 a[176:179], v2 offset:28672
  v_mfma_f32_16x16x32_bf16 v[108:111], a[148:151], a[20:23], v[108:111]
  v_exp_f32 v99, v99
  v_mfma_f32_16x16x32_bf16 v[108:111], a[144:147], a[16:19], v[108:111]
  v_cvt_pk_bf16_f32 v112, v96, v97
  v_fma_f32 v100, v100, s40, v20
  v_mfma_f32_16x16x32_bf16 v[224:227], a[224:227], v[116:119], v[224:227]
  v_exp_f32 v100, v100
  v_mfma_f32_16x16x32_bf16 v[228:231], a[228:231], v[116:119], v[228:231]
  v_cvt_pk_bf16_f32 v113, v98, v99
  v_fma_f32 v101, v101, s40, v20
  v_mfma_f32_16x16x32_bf16 v[232:235], a[232:235], v[116:119], v[232:235]
  v_exp_f32 v101, v101
  v_mfma_f32_16x16x32_bf16 v[236:239], a[236:239], v[116:119], v[236:239]
  v_fma_f32 v102, v102, s40, v20
  v_fma_f32 v103, v103, s40, v20
  v_mfma_f32_16x16x32_bf16 v[240:243], a[240:243], v[116:119], v[240:243]
  v_exp_f32 v102, v102
  v_mfma_f32_16x16x32_bf16 v[244:247], a[244:247], v[116:119], v[244:247]
  v_exp_f32 v103, v103
  v_mfma_f32_16x16x32_bf16 v[248:251], a[248:251], v[116:119], v[248:251]
  s_add_u32 s45, s45, 8192
  s_add_u32 m0, s44, 8192
  v_mfma_f32_16x16x32_bf16 v[252:255], a[252:255], v[116:119], v[252:255]
  v_cvt_pk_bf16_f32 v114, v100, v101
  v_cvt_pk_bf16_f32 v115, v102, v103
  v_mfma_f32_16x16x32_bf16 v[76:79], v[32:35], v[116:119], v[76:79]
  ds_read_b128 a[164:167], v3 offset:24576
  v_fma_f32 v104, v104, s40, v21
  v_mfma_f32_16x16x32_bf16 v[96:99], a[128:131], a[32:35], 0
  buffer_load_dwordx4 v14, s[20:23], s45 offen offset:0 lds
  buffer_load_dwordx4 v15, s[20:23], s45 offen offset:1024 lds
  buffer_load_dwordx4 v16, s[20:23], s45 offen offset:2048 lds
  buffer_load_dwordx4 v17, s[20:23], s45 offen offset:3072 lds
  v_mfma_f32_16x16x32_bf16 v[96:99], a[132:135], a[36:39], v[96:99]
  ds_read_b128 a[180:183], v3 offset:28672
  v_fma_f32 v105, v105, s40, v21
  v_mfma_f32_16x16x32_bf16 v[96:99], a[136:139], a[40:43], v[96:99]
  v_exp_f32 v104, v104
  v_mfma_f32_16x16x32_bf16 v[96:99], a[140:143], a[44:47], v[96:99]
  v_exp_f32 v105, v105
  v_mfma_f32_16x16x32_bf16 v[100:103], a[156:159], a[44:47], 0
  ds_read_b64_tr_b16 a[224:225], v6 offset:24576
  v_fma_f32 v106, v106, s40, v21
  v_mfma_f32_16x16x32_bf16 v[100:103], a[152:155], a[40:43], v[100:103]
  ds_read_b64_tr_b16 a[226:227], v6 offset:28672
  v_fma_f32 v107, v107, s40, v21
  v_mfma_f32_16x16x32_bf16 v[100:103], a[148:151], a[36:39], v[100:103]
  v_exp_f32 v106, v106
  v_mfma_f32_16x16x32_bf16 v[100:103], a[144:147], a[32:35], v[100:103]
  v_exp_f32 v107, v107
  v_mfma_f32_16x16x32_bf16 v[128:131], a[192:195], v[112:115], v[128:131]
  v_cvt_pk_bf16_f32 v116, v104, v105
  v_fma_f32 v108, v108, s40, v21
  v_mfma_f32_16x16x32_bf16 v[132:135], a[196:199], v[112:115], v[132:135]
  v_exp_f32 v108, v108
  v_mfma_f32_16x16x32_bf16 v[136:139], a[200:203], v[112:115], v[136:139]
  ds_read_b128 a[168:171], v4 offset:24576
  ds_read_b64_tr_b16 a[228:229], v7 offset:24576
  v_mfma_f32_16x16x32_bf16 v[140:143], a[204:207], v[112:115], v[140:143]
  v_cvt_pk_bf16_f32 v117, v106, v107
  v_fma_f32 v109, v109, s40, v21
  v_mfma_f32_16x16x32_bf16 v[144:147], a[208:211], v[112:115], v[144:147]
  ds_read_b64_tr_b16 a[230:231], v7 offset:28672
  ds_read_b128 a[184:187], v4 offset:28672
  v_mfma_f32_16x16x32_bf16 v[148:151], a[212:215], v[112:115], v[148:151]
  v_exp_f32 v109, v109
  v_mfma_f32_16x16x32_bf16 v[152:155], a[216:219], v[112:115], v[152:155]
  v_fma_f32 v110, v110, s40, v21
  v_fma_f32 v111, v111, s40, v21
  v_mfma_f32_16x16x32_bf16 v[156:159], a[220:223], v[112:115], v[156:159]
  ds_read_b64_tr_b16 a[232:233], v8 offset:24576
  v_exp_f32 v110, v110
  v_exp_f32 v111, v111
  v_mfma_f32_16x16x32_bf16 v[64:67], v[32:35], v[112:115], v[64:67]
  v_cvt_pk_bf16_f32 v118, v108, v109
  v_cvt_pk_bf16_f32 v119, v110, v111
  v_mfma_f32_16x16x32_bf16 v[104:107], a[128:131], a[48:51], 0
  ds_read_b64_tr_b16 a[234:235], v8 offset:28672
  v_fma_f32 v96, v96, s40, v22
  v_mfma_f32_16x16x32_bf16 v[104:107], a[132:135], a[52:55], v[104:107]
  ds_read_b128 a[172:175], v5 offset:24576
  v_fma_f32 v97, v97, s40, v22
  v_mfma_f32_16x16x32_bf16 v[104:107], a[136:139], a[56:59], v[104:107]
  ds_read_b64_tr_b16 a[236:237], v9 offset:24576
  ds_read_b64_tr_b16 a[238:239], v9 offset:28672
  v_mfma_f32_16x16x32_bf16 v[104:107], a[140:143], a[60:63], v[104:107]
  v_exp_f32 v96, v96
  v_mfma_f32_16x16x32_bf16 v[108:111], a[156:159], a[60:63], 0
  v_exp_f32 v97, v97
  v_mfma_f32_16x16x32_bf16 v[108:111], a[152:155], a[56:59], v[108:111]
  v_fma_f32 v98, v98, s40, v22
  v_fma_f32 v99, v99, s40, v22
  v_mfma_f32_16x16x32_bf16 v[108:111], a[148:151], a[52:55], v[108:111]
  v_exp_f32 v98, v98
  v_mfma_f32_16x16x32_bf16 v[108:111], a[144:147], a[48:51], v[108:111]
  v_exp_f32 v99, v99
  v_mfma_f32_16x16x32_bf16 v[160:163], a[192:195], v[116:119], v[160:163]
  ds_read_b128 a[188:191], v5 offset:28672
  ds_read_b64_tr_b16 a[240:241], v10 offset:24576
  v_mfma_f32_16x16x32_bf16 v[164:167], a[196:199], v[116:119], v[164:167]
  v_cvt_pk_bf16_f32 v112, v96, v97
  v_fma_f32 v100, v100, s40, v22
  v_mfma_f32_16x16x32_bf16 v[168:171], a[200:203], v[116:119], v[168:171]
  ds_read_b64_tr_b16 a[242:243], v10 offset:28672
  ds_read_b64_tr_b16 a[244:245], v11 offset:24576
  v_mfma_f32_16x16x32_bf16 v[172:175], a[204:207], v[116:119], v[172:175]
  v_exp_f32 v100, v100
  v_mfma_f32_16x16x32_bf16 v[176:179], a[208:211], v[116:119], v[176:179]
  v_cvt_pk_bf16_f32 v113, v98, v99
  v_fma_f32 v101, v101, s40, v22
  v_mfma_f32_16x16x32_bf16 v[180:183], a[212:215], v[116:119], v[180:183]
  v_exp_f32 v101, v101
  v_mfma_f32_16x16x32_bf16 v[184:187], a[216:219], v[116:119], v[184:187]
  v_fma_f32 v102, v102, s40, v22
  v_fma_f32 v103, v103, s40, v22
  v_mfma_f32_16x16x32_bf16 v[188:191], a[220:223], v[116:119], v[188:191]
  s_waitcnt vmcnt(16)
  ds_read_b128 a[80:83], v52 offset:4096
  ds_read_b128 a[84:87], v53 offset:4096
  ds_read_b64_tr_b16 a[246:247], v11 offset:28672
  v_exp_f32 v102, v102
  v_exp_f32 v103, v103
  v_mfma_f32_16x16x32_bf16 v[68:71], v[32:35], v[116:119], v[68:71]
  v_cvt_pk_bf16_f32 v114, v100, v101
  v_cvt_pk_bf16_f32 v115, v102, v103
  s_waitcnt lgkmcnt(6)
  v_mfma_f32_16x16x32_bf16 v[96:99], a[160:163], a[0:3], 0
  ds_read_b64_tr_b16 a[248:249], v12 offset:24576
  v_fma_f32 v104, v104, s40, v23
  v_mfma_f32_16x16x32_bf16 v[96:99], a[164:167], a[4:7], v[96:99]
  ds_read_b64_tr_b16 a[250:251], v12 offset:28672
  v_fma_f32 v105, v105, s40, v23
  v_mfma_f32_16x16x32_bf16 v[96:99], a[168:171], a[8:11], v[96:99]
  v_exp_f32 v104, v104
  v_mfma_f32_16x16x32_bf16 v[96:99], a[172:175], a[12:15], v[96:99]
  v_exp_f32 v105, v105
  v_mfma_f32_16x16x32_bf16 v[100:103], a[188:191], a[12:15], 0
  v_fma_f32 v106, v106, s40, v23
  v_fma_f32 v107, v107, s40, v23
  v_mfma_f32_16x16x32_bf16 v[100:103], a[184:187], a[8:11], v[100:103]
  ds_read_b64_tr_b16 a[252:253], v13 offset:24576
  ds_read_b64_tr_b16 a[254:255], v13 offset:28672
  v_mfma_f32_16x16x32_bf16 v[100:103], a[180:183], a[4:7], v[100:103]
  v_exp_f32 v106, v106
  v_mfma_f32_16x16x32_bf16 v[100:103], a[176:179], a[0:3], v[100:103]
  v_exp_f32 v107, v107
  v_mfma_f32_16x16x32_bf16 v[192:195], a[192:195], v[112:115], v[192:195]
  v_cvt_pk_bf16_f32 v116, v104, v105
  v_fma_f32 v108, v108, s40, v23
  v_mfma_f32_16x16x32_bf16 v[196:199], a[196:199], v[112:115], v[196:199]
  v_exp_f32 v108, v108
  v_mfma_f32_16x16x32_bf16 v[200:203], a[200:203], v[112:115], v[200:203]
  v_cvt_pk_bf16_f32 v117, v106, v107
  v_fma_f32 v109, v109, s40, v23
  v_mfma_f32_16x16x32_bf16 v[204:207], a[204:207], v[112:115], v[204:207]
  v_exp_f32 v109, v109
  v_mfma_f32_16x16x32_bf16 v[208:211], a[208:211], v[112:115], v[208:211]
  v_fma_f32 v110, v110, s40, v23
  v_fma_f32 v111, v111, s40, v23
  v_mfma_f32_16x16x32_bf16 v[212:215], a[212:215], v[112:115], v[212:215]
  s_add_u32 m0, s80, 1920
  v_fma_f32 v96, v96, s40, v20
  v_mfma_f32_16x16x32_bf16 v[216:219], a[216:219], v[112:115], v[216:219]
  v_exp_f32 v110, v110
  v_mfma_f32_16x16x32_bf16 v[220:223], a[220:223], v[112:115], v[220:223]
  v_exp_f32 v111, v111
  v_mfma_f32_16x16x32_bf16 v[72:75], v[32:35], v[112:115], v[72:75]
  buffer_load_dwordx4 v48, s[16:19], s67 offen offset:128 nt lds
  buffer_load_dwordx4 v49, s[16:19], s67 offen offset:1152 nt lds
  v_cvt_pk_bf16_f32 v118, v108, v109
  v_cvt_pk_bf16_f32 v119, v110, v111
  v_mfma_f32_16x16x32_bf16 v[104:107], a[160:163], a[16:19], 0
  ds_read_b128 a[128:131], v2 offset:32768
  v_fma_f32 v97, v97, s40, v20
  v_mfma_f32_16x16x32_bf16 v[104:107], a[164:167], a[20:23], v[104:107]
  v_exp_f32 v96, v96
  v_mfma_f32_16x16x32_bf16 v[104:107], a[168:171], a[24:27], v[104:107]
  v_exp_f32 v97, v97
  v_mfma_f32_16x16x32_bf16 v[104:107], a[172:175], a[28:31], v[104:107]
  v_fma_f32 v98, v98, s40, v20
  v_fma_f32 v99, v99, s40, v20
  v_mfma_f32_16x16x32_bf16 v[108:111], a[188:191], a[28:31], 0
  v_exp_f32 v98, v98
  v_mfma_f32_16x16x32_bf16 v[108:111], a[184:187], a[24:27], v[108:111]
  v_exp_f32 v99, v99
  v_mfma_f32_16x16x32_bf16 v[108:111], a[180:183], a[20:23], v[108:111]
  v_cvt_pk_bf16_f32 v112, v96, v97
  v_fma_f32 v100, v100, s40, v20
  v_mfma_f32_16x16x32_bf16 v[108:111], a[176:179], a[16:19], v[108:111]
  v_exp_f32 v100, v100
  v_mfma_f32_16x16x32_bf16 v[224:227], a[192:195], v[116:119], v[224:227]
  v_cvt_pk_bf16_f32 v113, v98, v99
  v_fma_f32 v101, v101, s40, v20
  v_mfma_f32_16x16x32_bf16 v[228:231], a[196:199], v[116:119], v[228:231]
  v_exp_f32 v101, v101
  v_mfma_f32_16x16x32_bf16 v[232:235], a[200:203], v[116:119], v[232:235]
  ds_read_b128 a[144:147], v2 offset:36864
  v_fma_f32 v102, v102, s40, v20
  v_mfma_f32_16x16x32_bf16 v[236:239], a[204:207], v[116:119], v[236:239]
  s_add_u32 s45, s45, 8192
  v_fma_f32 v103, v103, s40, v20
  v_mfma_f32_16x16x32_bf16 v[240:243], a[208:211], v[116:119], v[240:243]
  v_exp_f32 v102, v102
  v_mfma_f32_16x16x32_bf16 v[244:247], a[212:215], v[116:119], v[244:247]
  v_exp_f32 v103, v103
  v_mfma_f32_16x16x32_bf16 v[248:251], a[216:219], v[116:119], v[248:251]
  s_add_u32 m0, s44, 16384
  v_cvt_pk_bf16_f32 v114, v100, v101
  v_mfma_f32_16x16x32_bf16 v[252:255], a[220:223], v[116:119], v[252:255]
  ds_read_b128 a[132:135], v3 offset:32768
  v_cvt_pk_bf16_f32 v115, v102, v103
  v_mfma_f32_16x16x32_bf16 v[76:79], v[32:35], v[116:119], v[76:79]
  v_fma_f32 v104, v104, s40, v21
  v_fma_f32 v105, v105, s40, v21
  v_mfma_f32_16x16x32_bf16 v[96:99], a[160:163], a[32:35], 0
  buffer_load_dwordx4 v14, s[20:23], s45 offen offset:0 lds
  buffer_load_dwordx4 v15, s[20:23], s45 offen offset:1024 lds
  buffer_load_dwordx4 v16, s[20:23], s45 offen offset:2048 lds
  buffer_load_dwordx4 v17, s[20:23], s45 offen offset:3072 lds
  v_mfma_f32_16x16x32_bf16 v[96:99], a[164:167], a[36:39], v[96:99]
  v_exp_f32 v104, v104
  v_mfma_f32_16x16x32_bf16 v[96:99], a[168:171], a[40:43], v[96:99]
  v_exp_f32 v105, v105
  v_mfma_f32_16x16x32_bf16 v[96:99], a[172:175], a[44:47], v[96:99]
  ds_read_b128 a[148:151], v3 offset:36864
  ds_read_b64_tr_b16 a[192:193], v6 offset:32768
  v_mfma_f32_16x16x32_bf16 v[100:103], a[188:191], a[44:47], 0
  v_fma_f32 v106, v106, s40, v21
  v_fma_f32 v107, v107, s40, v21
  v_mfma_f32_16x16x32_bf16 v[100:103], a[184:187], a[40:43], v[100:103]
  v_exp_f32 v106, v106
  v_mfma_f32_16x16x32_bf16 v[100:103], a[180:183], a[36:39], v[100:103]
  ds_read_b64_tr_b16 a[194:195], v6 offset:36864
  ds_read_b128 a[136:139], v4 offset:32768
  v_mfma_f32_16x16x32_bf16 v[100:103], a[176:179], a[32:35], v[100:103]
  ds_read_b64_tr_b16 a[196:197], v7 offset:32768
  s_waitcnt lgkmcnt(8)
  v_mfma_f32_16x16x32_bf16 v[128:131], a[224:227], v[112:115], v[128:131]
  v_exp_f32 v107, v107
  v_mfma_f32_16x16x32_bf16 v[132:135], a[228:231], v[112:115], v[132:135]
  v_cvt_pk_bf16_f32 v116, v104, v105
  v_fma_f32 v108, v108, s40, v21
  v_mfma_f32_16x16x32_bf16 v[136:139], a[232:235], v[112:115], v[136:139]
  v_exp_f32 v108, v108
  v_mfma_f32_16x16x32_bf16 v[140:143], a[236:239], v[112:115], v[140:143]
  v_cvt_pk_bf16_f32 v117, v106, v107
  v_fma_f32 v109, v109, s40, v21
  v_mfma_f32_16x16x32_bf16 v[144:147], a[240:243], v[112:115], v[144:147]
  ds_read_b64_tr_b16 a[198:199], v7 offset:36864
  ds_read_b128 a[152:155], v4 offset:36864
  v_mfma_f32_16x16x32_bf16 v[148:151], a[244:247], v[112:115], v[148:151]
  v_exp_f32 v109, v109
  v_mfma_f32_16x16x32_bf16 v[152:155], a[248:251], v[112:115], v[152:155]
  v_fma_f32 v110, v110, s40, v21
  v_fma_f32 v111, v111, s40, v21
  v_mfma_f32_16x16x32_bf16 v[156:159], a[252:255], v[112:115], v[156:159]
  ds_read_b64_tr_b16 a[200:201], v8 offset:32768
  v_exp_f32 v110, v110
  v_exp_f32 v111, v111
  v_mfma_f32_16x16x32_bf16 v[64:67], v[32:35], v[112:115], v[64:67]
  v_cvt_pk_bf16_f32 v118, v108, v109
  v_cvt_pk_bf16_f32 v119, v110, v111
  v_mfma_f32_16x16x32_bf16 v[104:107], a[160:163], a[48:51], 0
  ds_read_b64_tr_b16 a[202:203], v8 offset:36864
  v_fma_f32 v96, v96, s40, v22
  v_mfma_f32_16x16x32_bf16 v[104:107], a[164:167], a[52:55], v[104:107]
  ds_read_b128 a[140:143], v5 offset:32768
  v_fma_f32 v97, v97, s40, v22
  v_mfma_f32_16x16x32_bf16 v[104:107], a[168:171], a[56:59], v[104:107]
  ds_read_b64_tr_b16 a[204:205], v9 offset:32768
  ds_read_b64_tr_b16 a[206:207], v9 offset:36864
  v_mfma_f32_16x16x32_bf16 v[104:107], a[172:175], a[60:63], v[104:107]
  v_exp_f32 v96, v96
  v_mfma_f32_16x16x32_bf16 v[108:111], a[188:191], a[60:63], 0
  v_exp_f32 v97, v97
  v_mfma_f32_16x16x32_bf16 v[108:111], a[184:187], a[56:59], v[108:111]
  v_fma_f32 v98, v98, s40, v22
  v_fma_f32 v99, v99, s40, v22
  v_mfma_f32_16x16x32_bf16 v[108:111], a[180:183], a[52:55], v[108:111]
  v_exp_f32 v98, v98
  v_mfma_f32_16x16x32_bf16 v[108:111], a[176:179], a[48:51], v[108:111]
  v_exp_f32 v99, v99
  v_mfma_f32_16x16x32_bf16 v[160:163], a[224:227], v[116:119], v[160:163]
  ds_read_b128 a[156:159], v5 offset:36864
  ds_read_b64_tr_b16 a[208:209], v10 offset:32768
  v_mfma_f32_16x16x32_bf16 v[164:167], a[228:231], v[116:119], v[164:167]
  v_cvt_pk_bf16_f32 v112, v96, v97
  v_fma_f32 v100, v100, s40, v22
  v_mfma_f32_16x16x32_bf16 v[168:171], a[232:235], v[116:119], v[168:171]
  ds_read_b64_tr_b16 a[210:211], v10 offset:36864
  ds_read_b64_tr_b16 a[212:213], v11 offset:32768
  v_mfma_f32_16x16x32_bf16 v[172:175], a[236:239], v[116:119], v[172:175]
  v_exp_f32 v100, v100
  v_mfma_f32_16x16x32_bf16 v[176:179], a[240:243], v[116:119], v[176:179]
  v_cvt_pk_bf16_f32 v113, v98, v99
  v_fma_f32 v101, v101, s40, v22
  v_mfma_f32_16x16x32_bf16 v[180:183], a[244:247], v[116:119], v[180:183]
  v_exp_f32 v101, v101
  v_mfma_f32_16x16x32_bf16 v[184:187], a[248:251], v[116:119], v[184:187]
  v_fma_f32 v102, v102, s40, v22
  v_fma_f32 v103, v103, s40, v22
  v_mfma_f32_16x16x32_bf16 v[188:191], a[252:255], v[116:119], v[188:191]
  s_waitcnt vmcnt(16)
  ds_read_b128 a[88:91], v52 offset:6144
  ds_read_b128 a[92:95], v53 offset:6144
  ds_read_b64_tr_b16 a[214:215], v11 offset:36864
  v_exp_f32 v102, v102
  v_exp_f32 v103, v103
  v_mfma_f32_16x16x32_bf16 v[68:71], v[32:35], v[116:119], v[68:71]
  v_cvt_pk_bf16_f32 v114, v100, v101
  v_cvt_pk_bf16_f32 v115, v102, v103
  s_waitcnt lgkmcnt(6)
  v_mfma_f32_16x16x32_bf16 v[96:99], a[128:131], a[0:3], 0
  ds_read_b64_tr_b16 a[216:217], v12 offset:32768
  v_fma_f32 v104, v104, s40, v23
  v_mfma_f32_16x16x32_bf16 v[96:99], a[132:135], a[4:7], v[96:99]
  ds_read_b64_tr_b16 a[218:219], v12 offset:36864
  v_fma_f32 v105, v105, s40, v23
  v_mfma_f32_16x16x32_bf16 v[96:99], a[136:139], a[8:11], v[96:99]
  v_exp_f32 v104, v104
  v_mfma_f32_16x16x32_bf16 v[96:99], a[140:143], a[12:15], v[96:99]
  v_exp_f32 v105, v105
  v_mfma_f32_16x16x32_bf16 v[100:103], a[156:159], a[12:15], 0
  v_fma_f32 v106, v106, s40, v23
  v_fma_f32 v107, v107, s40, v23
  v_mfma_f32_16x16x32_bf16 v[100:103], a[152:155], a[8:11], v[100:103]
  ds_read_b64_tr_b16 a[220:221], v13 offset:32768
  ds_read_b64_tr_b16 a[222:223], v13 offset:36864
  v_mfma_f32_16x16x32_bf16 v[100:103], a[148:151], a[4:7], v[100:103]
  v_exp_f32 v106, v106
  v_mfma_f32_16x16x32_bf16 v[100:103], a[144:147], a[0:3], v[100:103]
  v_exp_f32 v107, v107
  v_mfma_f32_16x16x32_bf16 v[192:195], a[224:227], v[112:115], v[192:195]
  v_cvt_pk_bf16_f32 v116, v104, v105
  v_fma_f32 v108, v108, s40, v23
  v_mfma_f32_16x16x32_bf16 v[196:199], a[228:231], v[112:115], v[196:199]
  v_exp_f32 v108, v108
  v_mfma_f32_16x16x32_bf16 v[200:203], a[232:235], v[112:115], v[200:203]
  v_cvt_pk_bf16_f32 v117, v106, v107
  v_fma_f32 v109, v109, s40, v23
  v_mfma_f32_16x16x32_bf16 v[204:207], a[236:239], v[112:115], v[204:207]
  v_exp_f32 v109, v109
  v_mfma_f32_16x16x32_bf16 v[208:211], a[240:243], v[112:115], v[208:211]
  s_add_u32 s67, s67, 4096
  v_fma_f32 v110, v110, s40, v23
  v_mfma_f32_16x16x32_bf16 v[212:215], a[244:247], v[112:115], v[212:215]
  s_add_u32 m0, s80, 4096
  v_fma_f32 v111, v111, s40, v23
  v_mfma_f32_16x16x32_bf16 v[216:219], a[248:251], v[112:115], v[216:219]
  v_exp_f32 v110, v110
  v_mfma_f32_16x16x32_bf16 v[220:223], a[252:255], v[112:115], v[220:223]
  v_exp_f32 v111, v111
  v_mfma_f32_16x16x32_bf16 v[72:75], v[32:35], v[112:115], v[72:75]
  buffer_load_dwordx4 v48, s[16:19], s67 offen offset:0 nt lds
  buffer_load_dwordx4 v49, s[16:19], s67 offen offset:1024 nt lds
  v_cvt_pk_bf16_f32 v118, v108, v109
  v_cvt_pk_bf16_f32 v119, v110, v111
  s_waitcnt lgkmcnt(0)
  s_barrier
  v_mfma_f32_16x16x32_bf16 v[104:107], a[128:131], a[16:19], 0
  v_fma_f32 v96, v96, s40, v20
  v_fma_f32 v97, v97, s40, v20
  v_mfma_f32_16x16x32_bf16 v[104:107], a[132:135], a[20:23], v[104:107]
  v_exp_f32 v96, v96
  v_mfma_f32_16x16x32_bf16 v[104:107], a[136:139], a[24:27], v[104:107]
  v_exp_f32 v97, v97
  v_mfma_f32_16x16x32_bf16 v[104:107], a[140:143], a[28:31], v[104:107]
  v_fma_f32 v98, v98, s40, v20
  v_fma_f32 v99, v99, s40, v20
  v_mfma_f32_16x16x32_bf16 v[108:111], a[156:159], a[28:31], 0
  v_exp_f32 v98, v98
  v_mfma_f32_16x16x32_bf16 v[108:111], a[152:155], a[24:27], v[108:111]
  ds_read_b128 a[160:163], v2 offset:40960
  ds_read_b128 a[176:179], v2 offset:45056
  v_mfma_f32_16x16x32_bf16 v[108:111], a[148:151], a[20:23], v[108:111]
  v_exp_f32 v99, v99
  v_mfma_f32_16x16x32_bf16 v[108:111], a[144:147], a[16:19], v[108:111]
  v_cvt_pk_bf16_f32 v112, v96, v97
  v_fma_f32 v100, v100, s40, v20
  v_mfma_f32_16x16x32_bf16 v[224:227], a[224:227], v[116:119], v[224:227]
  v_exp_f32 v100, v100
  v_mfma_f32_16x16x32_bf16 v[228:231], a[228:231], v[116:119], v[228:231]
  v_cvt_pk_bf16_f32 v113, v98, v99
  v_fma_f32 v101, v101, s40, v20
  v_mfma_f32_16x16x32_bf16 v[232:235], a[232:235], v[116:119], v[232:235]
  v_exp_f32 v101, v101
  v_mfma_f32_16x16x32_bf16 v[236:239], a[236:239], v[116:119], v[236:239]
  v_fma_f32 v102, v102, s40, v20
  v_fma_f32 v103, v103, s40, v20
  v_mfma_f32_16x16x32_bf16 v[240:243], a[240:243], v[116:119], v[240:243]
  v_exp_f32 v102, v102
  v_mfma_f32_16x16x32_bf16 v[244:247], a[244:247], v[116:119], v[244:247]
  v_exp_f32 v103, v103
  v_mfma_f32_16x16x32_bf16 v[248:251], a[248:251], v[116:119], v[248:251]
  s_add_u32 s45, s45, 8192
  s_add_u32 m0, s44, 24576
  v_mfma_f32_16x16x32_bf16 v[252:255], a[252:255], v[116:119], v[252:255]
  v_cvt_pk_bf16_f32 v114, v100, v101
  v_cvt_pk_bf16_f32 v115, v102, v103
  v_mfma_f32_16x16x32_bf16 v[76:79], v[32:35], v[116:119], v[76:79]
  ds_read_b128 a[164:167], v3 offset:40960
  v_fma_f32 v104, v104, s40, v21
  v_mfma_f32_16x16x32_bf16 v[96:99], a[128:131], a[32:35], 0
  buffer_load_dwordx4 v14, s[20:23], s45 offen offset:0 lds
  buffer_load_dwordx4 v15, s[20:23], s45 offen offset:1024 lds
  buffer_load_dwordx4 v16, s[20:23], s45 offen offset:2048 lds
  buffer_load_dwordx4 v17, s[20:23], s45 offen offset:3072 lds
  v_mfma_f32_16x16x32_bf16 v[96:99], a[132:135], a[36:39], v[96:99]
  ds_read_b128 a[180:183], v3 offset:45056
  v_fma_f32 v105, v105, s40, v21
  v_mfma_f32_16x16x32_bf16 v[96:99], a[136:139], a[40:43], v[96:99]
  v_exp_f32 v104, v104
  v_mfma_f32_16x16x32_bf16 v[96:99], a[140:143], a[44:47], v[96:99]
  v_exp_f32 v105, v105
  v_mfma_f32_16x16x32_bf16 v[100:103], a[156:159], a[44:47], 0
  ds_read_b64_tr_b16 a[224:225], v6 offset:40960
  v_fma_f32 v106, v106, s40, v21
  v_mfma_f32_16x16x32_bf16 v[100:103], a[152:155], a[40:43], v[100:103]
  ds_read_b64_tr_b16 a[226:227], v6 offset:45056
  v_fma_f32 v107, v107, s40, v21
  v_mfma_f32_16x16x32_bf16 v[100:103], a[148:151], a[36:39], v[100:103]
  v_exp_f32 v106, v106
  v_mfma_f32_16x16x32_bf16 v[100:103], a[144:147], a[32:35], v[100:103]
  v_exp_f32 v107, v107
  v_mfma_f32_16x16x32_bf16 v[128:131], a[192:195], v[112:115], v[128:131]
  v_cvt_pk_bf16_f32 v116, v104, v105
  v_fma_f32 v108, v108, s40, v21
  v_mfma_f32_16x16x32_bf16 v[132:135], a[196:199], v[112:115], v[132:135]
  v_exp_f32 v108, v108
  v_mfma_f32_16x16x32_bf16 v[136:139], a[200:203], v[112:115], v[136:139]
  ds_read_b128 a[168:171], v4 offset:40960
  ds_read_b64_tr_b16 a[228:229], v7 offset:40960
  v_mfma_f32_16x16x32_bf16 v[140:143], a[204:207], v[112:115], v[140:143]
  v_cvt_pk_bf16_f32 v117, v106, v107
  v_fma_f32 v109, v109, s40, v21
  v_mfma_f32_16x16x32_bf16 v[144:147], a[208:211], v[112:115], v[144:147]
  ds_read_b64_tr_b16 a[230:231], v7 offset:45056
  ds_read_b128 a[184:187], v4 offset:45056
  v_mfma_f32_16x16x32_bf16 v[148:151], a[212:215], v[112:115], v[148:151]
  v_exp_f32 v109, v109
  v_mfma_f32_16x16x32_bf16 v[152:155], a[216:219], v[112:115], v[152:155]
  v_fma_f32 v110, v110, s40, v21
  v_fma_f32 v111, v111, s40, v21
  v_mfma_f32_16x16x32_bf16 v[156:159], a[220:223], v[112:115], v[156:159]
  ds_read_b64_tr_b16 a[232:233], v8 offset:40960
  v_exp_f32 v110, v110
  v_exp_f32 v111, v111
  v_mfma_f32_16x16x32_bf16 v[64:67], v[32:35], v[112:115], v[64:67]
  v_cvt_pk_bf16_f32 v118, v108, v109
  v_cvt_pk_bf16_f32 v119, v110, v111
  v_mfma_f32_16x16x32_bf16 v[104:107], a[128:131], a[48:51], 0
  ds_read_b64_tr_b16 a[234:235], v8 offset:45056
  v_fma_f32 v96, v96, s40, v22
  v_mfma_f32_16x16x32_bf16 v[104:107], a[132:135], a[52:55], v[104:107]
  ds_read_b128 a[172:175], v5 offset:40960
  v_fma_f32 v97, v97, s40, v22
  v_mfma_f32_16x16x32_bf16 v[104:107], a[136:139], a[56:59], v[104:107]
  ds_read_b64_tr_b16 a[236:237], v9 offset:40960
  ds_read_b64_tr_b16 a[238:239], v9 offset:45056
  v_mfma_f32_16x16x32_bf16 v[104:107], a[140:143], a[60:63], v[104:107]
  v_exp_f32 v96, v96
  v_mfma_f32_16x16x32_bf16 v[108:111], a[156:159], a[60:63], 0
  v_exp_f32 v97, v97
  v_mfma_f32_16x16x32_bf16 v[108:111], a[152:155], a[56:59], v[108:111]
  v_fma_f32 v98, v98, s40, v22
  v_fma_f32 v99, v99, s40, v22
  v_mfma_f32_16x16x32_bf16 v[108:111], a[148:151], a[52:55], v[108:111]
  v_exp_f32 v98, v98
  v_mfma_f32_16x16x32_bf16 v[108:111], a[144:147], a[48:51], v[108:111]
  v_exp_f32 v99, v99
  v_mfma_f32_16x16x32_bf16 v[160:163], a[192:195], v[116:119], v[160:163]
  ds_read_b128 a[188:191], v5 offset:45056
  ds_read_b64_tr_b16 a[240:241], v10 offset:40960
  v_mfma_f32_16x16x32_bf16 v[164:167], a[196:199], v[116:119], v[164:167]
  v_cvt_pk_bf16_f32 v112, v96, v97
  v_fma_f32 v100, v100, s40, v22
  v_mfma_f32_16x16x32_bf16 v[168:171], a[200:203], v[116:119], v[168:171]
  ds_read_b64_tr_b16 a[242:243], v10 offset:45056
  ds_read_b64_tr_b16 a[244:245], v11 offset:40960
  v_mfma_f32_16x16x32_bf16 v[172:175], a[204:207], v[116:119], v[172:175]
  v_exp_f32 v100, v100
  v_mfma_f32_16x16x32_bf16 v[176:179], a[208:211], v[116:119], v[176:179]
  v_cvt_pk_bf16_f32 v113, v98, v99
  v_fma_f32 v101, v101, s40, v22
  v_mfma_f32_16x16x32_bf16 v[180:183], a[212:215], v[116:119], v[180:183]
  v_exp_f32 v101, v101
  v_mfma_f32_16x16x32_bf16 v[184:187], a[216:219], v[116:119], v[184:187]
  v_fma_f32 v102, v102, s40, v22
  v_fma_f32 v103, v103, s40, v22
  v_mfma_f32_16x16x32_bf16 v[188:191], a[220:223], v[116:119], v[188:191]
  ds_read_b64_tr_b16 a[246:247], v11 offset:45056
  v_exp_f32 v102, v102
  v_exp_f32 v103, v103
  v_mfma_f32_16x16x32_bf16 v[68:71], v[32:35], v[116:119], v[68:71]
  v_cvt_pk_bf16_f32 v114, v100, v101
  v_cvt_pk_bf16_f32 v115, v102, v103
  s_waitcnt lgkmcnt(4)
  v_mfma_f32_16x16x32_bf16 v[96:99], a[160:163], a[0:3], 0
  ds_read_b64_tr_b16 a[248:249], v12 offset:40960
  v_fma_f32 v104, v104, s40, v23
  v_mfma_f32_16x16x32_bf16 v[96:99], a[164:167], a[4:7], v[96:99]
  ds_read_b64_tr_b16 a[250:251], v12 offset:45056
  v_fma_f32 v105, v105, s40, v23
  v_mfma_f32_16x16x32_bf16 v[96:99], a[168:171], a[8:11], v[96:99]
  v_exp_f32 v104, v104
  v_mfma_f32_16x16x32_bf16 v[96:99], a[172:175], a[12:15], v[96:99]
  v_exp_f32 v105, v105
  v_mfma_f32_16x16x32_bf16 v[100:103], a[188:191], a[12:15], 0
  v_fma_f32 v106, v106, s40, v23
  v_fma_f32 v107, v107, s40, v23
  v_mfma_f32_16x16x32_bf16 v[100:103], a[184:187], a[8:11], v[100:103]
  ds_read_b64_tr_b16 a[252:253], v13 offset:40960
  ds_read_b64_tr_b16 a[254:255], v13 offset:45056
  v_mfma_f32_16x16x32_bf16 v[100:103], a[180:183], a[4:7], v[100:103]
  v_exp_f32 v106, v106
  v_mfma_f32_16x16x32_bf16 v[100:103], a[176:179], a[0:3], v[100:103]
  v_exp_f32 v107, v107
  v_mfma_f32_16x16x32_bf16 v[192:195], a[192:195], v[112:115], v[192:195]
  v_cvt_pk_bf16_f32 v116, v104, v105
  v_fma_f32 v108, v108, s40, v23
  v_mfma_f32_16x16x32_bf16 v[196:199], a[196:199], v[112:115], v[196:199]
  v_exp_f32 v108, v108
  v_mfma_f32_16x16x32_bf16 v[200:203], a[200:203], v[112:115], v[200:203]
  v_cvt_pk_bf16_f32 v117, v106, v107
  v_fma_f32 v109, v109, s40, v23
  v_mfma_f32_16x16x32_bf16 v[204:207], a[204:207], v[112:115], v[204:207]
  v_exp_f32 v109, v109
  v_mfma_f32_16x16x32_bf16 v[208:211], a[208:211], v[112:115], v[208:211]
  v_fma_f32 v110, v110, s40, v23
  v_fma_f32 v111, v111, s40, v23
  v_mfma_f32_16x16x32_bf16 v[212:215], a[212:215], v[112:115], v[212:215]
  s_add_u32 m0, s80, 6016
  v_fma_f32 v96, v96, s40, v20
  v_mfma_f32_16x16x32_bf16 v[216:219], a[216:219], v[112:115], v[216:219]
  v_exp_f32 v110, v110
  v_mfma_f32_16x16x32_bf16 v[220:223], a[220:223], v[112:115], v[220:223]
  v_exp_f32 v111, v111
  v_mfma_f32_16x16x32_bf16 v[72:75], v[32:35], v[112:115], v[72:75]
  buffer_load_dwordx4 v48, s[16:19], s67 offen offset:128 nt lds
  buffer_load_dwordx4 v49, s[16:19], s67 offen offset:1152 nt lds
  v_cvt_pk_bf16_f32 v118, v108, v109
  v_cvt_pk_bf16_f32 v119, v110, v111
  v_mfma_f32_16x16x32_bf16 v[104:107], a[160:163], a[16:19], 0
  ds_read_b128 a[128:131], v2 offset:49152
  v_fma_f32 v97, v97, s40, v20
  v_mfma_f32_16x16x32_bf16 v[104:107], a[164:167], a[20:23], v[104:107]
  v_exp_f32 v96, v96
  v_mfma_f32_16x16x32_bf16 v[104:107], a[168:171], a[24:27], v[104:107]
  v_exp_f32 v97, v97
  v_mfma_f32_16x16x32_bf16 v[104:107], a[172:175], a[28:31], v[104:107]
  v_fma_f32 v98, v98, s40, v20
  v_fma_f32 v99, v99, s40, v20
  v_mfma_f32_16x16x32_bf16 v[108:111], a[188:191], a[28:31], 0
  v_exp_f32 v98, v98
  v_mfma_f32_16x16x32_bf16 v[108:111], a[184:187], a[24:27], v[108:111]
  v_exp_f32 v99, v99
  v_mfma_f32_16x16x32_bf16 v[108:111], a[180:183], a[20:23], v[108:111]
  v_cvt_pk_bf16_f32 v112, v96, v97
  v_fma_f32 v100, v100, s40, v20
  v_mfma_f32_16x16x32_bf16 v[108:111], a[176:179], a[16:19], v[108:111]
  v_exp_f32 v100, v100
  v_mfma_f32_16x16x32_bf16 v[224:227], a[192:195], v[116:119], v[224:227]
  v_cvt_pk_bf16_f32 v113, v98, v99
  v_fma_f32 v101, v101, s40, v20
  v_mfma_f32_16x16x32_bf16 v[228:231], a[196:199], v[116:119], v[228:231]
  v_exp_f32 v101, v101
  v_mfma_f32_16x16x32_bf16 v[232:235], a[200:203], v[116:119], v[232:235]
  ds_read_b128 a[144:147], v2 offset:53248
  v_fma_f32 v102, v102, s40, v20
  v_mfma_f32_16x16x32_bf16 v[236:239], a[204:207], v[116:119], v[236:239]
  s_add_u32 s45, s45, 8192
  v_fma_f32 v103, v103, s40, v20
  v_mfma_f32_16x16x32_bf16 v[240:243], a[208:211], v[116:119], v[240:243]
  v_exp_f32 v102, v102
  v_mfma_f32_16x16x32_bf16 v[244:247], a[212:215], v[116:119], v[244:247]
  v_exp_f32 v103, v103
  v_mfma_f32_16x16x32_bf16 v[248:251], a[216:219], v[116:119], v[248:251]
  s_add_u32 m0, s44, 32768
  v_cvt_pk_bf16_f32 v114, v100, v101
  v_mfma_f32_16x16x32_bf16 v[252:255], a[220:223], v[116:119], v[252:255]
  ds_read_b128 a[132:135], v3 offset:49152
  v_cvt_pk_bf16_f32 v115, v102, v103
  v_mfma_f32_16x16x32_bf16 v[76:79], v[32:35], v[116:119], v[76:79]
  v_fma_f32 v104, v104, s40, v21
  v_fma_f32 v105, v105, s40, v21
  v_mfma_f32_16x16x32_bf16 v[96:99], a[160:163], a[32:35], 0
  buffer_load_dwordx4 v14, s[20:23], s45 offen offset:0 lds
  buffer_load_dwordx4 v15, s[20:23], s45 offen offset:1024 lds
  buffer_load_dwordx4 v16, s[20:23], s45 offen offset:2048 lds
  buffer_load_dwordx4 v17, s[20:23], s45 offen offset:3072 lds
  v_mfma_f32_16x16x32_bf16 v[96:99], a[164:167], a[36:39], v[96:99]
  v_exp_f32 v104, v104
  v_mfma_f32_16x16x32_bf16 v[96:99], a[168:171], a[40:43], v[96:99]
  v_exp_f32 v105, v105
  v_mfma_f32_16x16x32_bf16 v[96:99], a[172:175], a[44:47], v[96:99]
  ds_read_b128 a[148:151], v3 offset:53248
  ds_read_b64_tr_b16 a[192:193], v6 offset:49152
  v_mfma_f32_16x16x32_bf16 v[100:103], a[188:191], a[44:47], 0
  v_fma_f32 v106, v106, s40, v21
  v_fma_f32 v107, v107, s40, v21
  v_mfma_f32_16x16x32_bf16 v[100:103], a[184:187], a[40:43], v[100:103]
  v_exp_f32 v106, v106
  v_mfma_f32_16x16x32_bf16 v[100:103], a[180:183], a[36:39], v[100:103]
  buffer_store_dwordx4 a[104:107], v19, s[24:27], s90 offen offset:2048 sc0 sc1
  buffer_store_dwordx4 a[108:111], v19, s[24:27], s90 offen offset:3072 sc0 sc1
  v_mfma_f32_16x16x32_bf16 v[100:103], a[176:179], a[32:35], v[100:103]
  ds_read_b64_tr_b16 a[194:195], v6 offset:53248
  s_waitcnt lgkmcnt(6)
  v_mfma_f32_16x16x32_bf16 v[128:131], a[224:227], v[112:115], v[128:131]
  v_exp_f32 v107, v107
  v_mfma_f32_16x16x32_bf16 v[132:135], a[228:231], v[112:115], v[132:135]
  v_cvt_pk_bf16_f32 v116, v104, v105
  v_fma_f32 v108, v108, s40, v21
  v_mfma_f32_16x16x32_bf16 v[136:139], a[232:235], v[112:115], v[136:139]
  ds_read_b128 a[136:139], v4 offset:49152
  ds_read_b64_tr_b16 a[196:197], v7 offset:49152
  v_mfma_f32_16x16x32_bf16 v[140:143], a[236:239], v[112:115], v[140:143]
  v_exp_f32 v108, v108
  v_mfma_f32_16x16x32_bf16 v[144:147], a[240:243], v[112:115], v[144:147]
  ds_read_b64_tr_b16 a[198:199], v7 offset:53248
  v_cvt_pk_bf16_f32 v117, v106, v107
  v_mfma_f32_16x16x32_bf16 v[148:151], a[244:247], v[112:115], v[148:151]
  ds_read_b128 a[152:155], v4 offset:53248
  v_fma_f32 v109, v109, s40, v21
  v_mfma_f32_16x16x32_bf16 v[152:155], a[248:251], v[112:115], v[152:155]
  v_exp_f32 v109, v109
  v_mfma_f32_16x16x32_bf16 v[156:159], a[252:255], v[112:115], v[156:159]
  ds_read_b64_tr_b16 a[200:201], v8 offset:49152
  v_fma_f32 v110, v110, s40, v21
  v_fma_f32 v111, v111, s40, v21
  v_exp_f32 v110, v110
  v_exp_f32 v111, v111
  v_mfma_f32_16x16x32_bf16 v[64:67], v[32:35], v[112:115], v[64:67]
  v_cvt_pk_bf16_f32 v118, v108, v109
  v_cvt_pk_bf16_f32 v119, v110, v111
  v_mfma_f32_16x16x32_bf16 v[104:107], a[160:163], a[48:51], 0
  ds_read_b64_tr_b16 a[202:203], v8 offset:53248
  v_fma_f32 v96, v96, s40, v22
  v_mfma_f32_16x16x32_bf16 v[104:107], a[164:167], a[52:55], v[104:107]
  ds_read_b128 a[140:143], v5 offset:49152
  v_fma_f32 v97, v97, s40, v22
  v_mfma_f32_16x16x32_bf16 v[104:107], a[168:171], a[56:59], v[104:107]
  ds_read_b64_tr_b16 a[204:205], v9 offset:49152
  ds_read_b64_tr_b16 a[206:207], v9 offset:53248
  v_mfma_f32_16x16x32_bf16 v[104:107], a[172:175], a[60:63], v[104:107]
  v_exp_f32 v96, v96
  v_mfma_f32_16x16x32_bf16 v[108:111], a[188:191], a[60:63], 0
  v_exp_f32 v97, v97
  v_mfma_f32_16x16x32_bf16 v[108:111], a[184:187], a[56:59], v[108:111]
  v_fma_f32 v98, v98, s40, v22
  v_fma_f32 v99, v99, s40, v22
  v_mfma_f32_16x16x32_bf16 v[108:111], a[180:183], a[52:55], v[108:111]
  v_exp_f32 v98, v98
  v_mfma_f32_16x16x32_bf16 v[108:111], a[176:179], a[48:51], v[108:111]
  v_exp_f32 v99, v99
  v_mfma_f32_16x16x32_bf16 v[160:163], a[224:227], v[116:119], v[160:163]
  ds_read_b128 a[156:159], v5 offset:53248
  ds_read_b64_tr_b16 a[208:209], v10 offset:49152
  v_mfma_f32_16x16x32_bf16 v[164:167], a[228:231], v[116:119], v[164:167]
  v_cvt_pk_bf16_f32 v112, v96, v97
  v_fma_f32 v100, v100, s40, v22
  v_mfma_f32_16x16x32_bf16 v[168:171], a[232:235], v[116:119], v[168:171]
  ds_read_b64_tr_b16 a[210:211], v10 offset:53248
  ds_read_b64_tr_b16 a[212:213], v11 offset:49152
  v_mfma_f32_16x16x32_bf16 v[172:175], a[236:239], v[116:119], v[172:175]
  v_exp_f32 v100, v100
  v_mfma_f32_16x16x32_bf16 v[176:179], a[240:243], v[116:119], v[176:179]
  v_cvt_pk_bf16_f32 v113, v98, v99
  v_fma_f32 v101, v101, s40, v22
  v_mfma_f32_16x16x32_bf16 v[180:183], a[244:247], v[116:119], v[180:183]
  v_exp_f32 v101, v101
  v_mfma_f32_16x16x32_bf16 v[184:187], a[248:251], v[116:119], v[184:187]
  v_fma_f32 v102, v102, s40, v22
  v_fma_f32 v103, v103, s40, v22
  v_mfma_f32_16x16x32_bf16 v[188:191], a[252:255], v[116:119], v[188:191]
  ds_read_b64_tr_b16 a[214:215], v11 offset:53248
  v_exp_f32 v102, v102
  v_exp_f32 v103, v103
  v_mfma_f32_16x16x32_bf16 v[68:71], v[32:35], v[116:119], v[68:71]
  v_cvt_pk_bf16_f32 v114, v100, v101
  v_cvt_pk_bf16_f32 v115, v102, v103
  s_waitcnt lgkmcnt(4)
  v_mfma_f32_16x16x32_bf16 v[96:99], a[128:131], a[0:3], 0
  ds_read_b64_tr_b16 a[216:217], v12 offset:49152
  v_fma_f32 v104, v104, s40, v23
  v_mfma_f32_16x16x32_bf16 v[96:99], a[132:135], a[4:7], v[96:99]
  ds_read_b64_tr_b16 a[218:219], v12 offset:53248
  v_fma_f32 v105, v105, s40, v23
  v_mfma_f32_16x16x32_bf16 v[96:99], a[136:139], a[8:11], v[96:99]
  v_exp_f32 v104, v104
  v_mfma_f32_16x16x32_bf16 v[96:99], a[140:143], a[12:15], v[96:99]
  v_exp_f32 v105, v105
  v_mfma_f32_16x16x32_bf16 v[100:103], a[156:159], a[12:15], 0
  v_fma_f32 v106, v106, s40, v23
  v_fma_f32 v107, v107, s40, v23
  v_mfma_f32_16x16x32_bf16 v[100:103], a[152:155], a[8:11], v[100:103]
  ds_read_b64_tr_b16 a[220:221], v13 offset:49152
  ds_read_b64_tr_b16 a[222:223], v13 offset:53248
  v_mfma_f32_16x16x32_bf16 v[100:103], a[148:151], a[4:7], v[100:103]
  v_exp_f32 v106, v106
  v_mfma_f32_16x16x32_bf16 v[100:103], a[144:147], a[0:3], v[100:103]
  v_exp_f32 v107, v107
  v_mfma_f32_16x16x32_bf16 v[192:195], a[224:227], v[112:115], v[192:195]
  v_cvt_pk_bf16_f32 v116, v104, v105
  v_fma_f32 v108, v108, s40, v23
  v_mfma_f32_16x16x32_bf16 v[196:199], a[228:231], v[112:115], v[196:199]
  v_exp_f32 v108, v108
  v_mfma_f32_16x16x32_bf16 v[200:203], a[232:235], v[112:115], v[200:203]
  v_cvt_pk_bf16_f32 v117, v106, v107
  v_fma_f32 v109, v109, s40, v23
  v_mfma_f32_16x16x32_bf16 v[204:207], a[236:239], v[112:115], v[204:207]
  v_exp_f32 v109, v109
  v_mfma_f32_16x16x32_bf16 v[208:211], a[240:243], v[112:115], v[208:211]
  v_fma_f32 v110, v110, s40, v23
  v_fma_f32 v111, v111, s40, v23
  v_mfma_f32_16x16x32_bf16 v[212:215], a[244:247], v[112:115], v[212:215]
  v_exp_f32 v110, v110
  v_mfma_f32_16x16x32_bf16 v[216:219], a[248:251], v[112:115], v[216:219]
  v_exp_f32 v111, v111
  v_mfma_f32_16x16x32_bf16 v[220:223], a[252:255], v[112:115], v[220:223]
  v_cvt_pk_bf16_f32 v118, v108, v109
  v_cvt_pk_bf16_f32 v119, v110, v111
  v_mfma_f32_16x16x32_bf16 v[72:75], v[32:35], v[112:115], v[72:75]
  s_waitcnt vmcnt(26) lgkmcnt(0)
  s_barrier
  v_mfma_f32_16x16x32_bf16 v[104:107], a[128:131], a[16:19], 0
  v_fma_f32 v96, v96, s40, v20
  v_fma_f32 v97, v97, s40, v20
  v_mfma_f32_16x16x32_bf16 v[104:107], a[132:135], a[20:23], v[104:107]
  v_exp_f32 v96, v96
  v_mfma_f32_16x16x32_bf16 v[104:107], a[136:139], a[24:27], v[104:107]
  v_exp_f32 v97, v97
  v_mfma_f32_16x16x32_bf16 v[104:107], a[140:143], a[28:31], v[104:107]
  v_fma_f32 v98, v98, s40, v20
  v_fma_f32 v99, v99, s40, v20
  v_mfma_f32_16x16x32_bf16 v[108:111], a[156:159], a[28:31], 0
  v_exp_f32 v98, v98
  v_mfma_f32_16x16x32_bf16 v[108:111], a[152:155], a[24:27], v[108:111]
  ds_read_b128 a[160:163], v2 offset:57344
  ds_read_b128 a[176:179], v2 offset:61440
  v_mfma_f32_16x16x32_bf16 v[108:111], a[148:151], a[20:23], v[108:111]
  v_exp_f32 v99, v99
  v_mfma_f32_16x16x32_bf16 v[108:111], a[144:147], a[16:19], v[108:111]
  v_cvt_pk_bf16_f32 v112, v96, v97
  v_fma_f32 v100, v100, s40, v20
  v_mfma_f32_16x16x32_bf16 v[224:227], a[224:227], v[116:119], v[224:227]
  v_exp_f32 v100, v100
  v_mfma_f32_16x16x32_bf16 v[228:231], a[228:231], v[116:119], v[228:231]
  v_cvt_pk_bf16_f32 v113, v98, v99
  v_fma_f32 v101, v101, s40, v20
  v_mfma_f32_16x16x32_bf16 v[232:235], a[232:235], v[116:119], v[232:235]
  v_exp_f32 v101, v101
  v_mfma_f32_16x16x32_bf16 v[236:239], a[236:239], v[116:119], v[236:239]
  v_fma_f32 v102, v102, s40, v20
  v_fma_f32 v103, v103, s40, v20
  v_mfma_f32_16x16x32_bf16 v[240:243], a[240:243], v[116:119], v[240:243]
  v_exp_f32 v102, v102
  v_mfma_f32_16x16x32_bf16 v[244:247], a[244:247], v[116:119], v[244:247]
  v_exp_f32 v103, v103
  v_mfma_f32_16x16x32_bf16 v[248:251], a[248:251], v[116:119], v[248:251]
  s_add_u32 s45, s45, 8192
  s_add_u32 m0, s44, 40960
  v_mfma_f32_16x16x32_bf16 v[252:255], a[252:255], v[116:119], v[252:255]
  v_cvt_pk_bf16_f32 v114, v100, v101
  v_cvt_pk_bf16_f32 v115, v102, v103
  v_mfma_f32_16x16x32_bf16 v[76:79], v[32:35], v[116:119], v[76:79]
  ds_read_b128 a[164:167], v3 offset:57344
  v_fma_f32 v104, v104, s40, v21
  v_mfma_f32_16x16x32_bf16 v[96:99], a[128:131], a[32:35], 0
  buffer_load_dwordx4 v14, s[20:23], s45 offen offset:0 lds
  buffer_load_dwordx4 v15, s[20:23], s45 offen offset:1024 lds
  buffer_load_dwordx4 v16, s[20:23], s45 offen offset:2048 lds
  buffer_load_dwordx4 v17, s[20:23], s45 offen offset:3072 lds
  v_mfma_f32_16x16x32_bf16 v[96:99], a[132:135], a[36:39], v[96:99]
  ds_read_b128 a[180:183], v3 offset:61440
  v_fma_f32 v105, v105, s40, v21
  v_mfma_f32_16x16x32_bf16 v[96:99], a[136:139], a[40:43], v[96:99]
  v_exp_f32 v104, v104
  v_mfma_f32_16x16x32_bf16 v[96:99], a[140:143], a[44:47], v[96:99]
  v_exp_f32 v105, v105
  v_mfma_f32_16x16x32_bf16 v[100:103], a[156:159], a[44:47], 0
  ds_read_b64_tr_b16 a[224:225], v6 offset:57344
  v_fma_f32 v106, v106, s40, v21
  v_mfma_f32_16x16x32_bf16 v[100:103], a[152:155], a[40:43], v[100:103]
  ds_read_b64_tr_b16 a[226:227], v6 offset:61440
  v_fma_f32 v107, v107, s40, v21
  v_mfma_f32_16x16x32_bf16 v[100:103], a[148:151], a[36:39], v[100:103]
  buffer_store_dwordx4 a[112:115], v19, s[24:27], s91 offen offset:0 sc0 sc1
  buffer_store_dwordx4 a[116:119], v19, s[24:27], s91 offen offset:1024 sc0 sc1
  v_mfma_f32_16x16x32_bf16 v[100:103], a[144:147], a[32:35], v[100:103]
  v_exp_f32 v106, v106
  v_mfma_f32_16x16x32_bf16 v[128:131], a[192:195], v[112:115], v[128:131]
  v_exp_f32 v107, v107
  v_mfma_f32_16x16x32_bf16 v[132:135], a[196:199], v[112:115], v[132:135]
  v_cvt_pk_bf16_f32 v116, v104, v105
  v_fma_f32 v108, v108, s40, v21
  v_mfma_f32_16x16x32_bf16 v[136:139], a[200:203], v[112:115], v[136:139]
  ds_read_b128 a[168:171], v4 offset:57344
  ds_read_b64_tr_b16 a[228:229], v7 offset:57344
  v_mfma_f32_16x16x32_bf16 v[140:143], a[204:207], v[112:115], v[140:143]
  v_exp_f32 v108, v108
  v_mfma_f32_16x16x32_bf16 v[144:147], a[208:211], v[112:115], v[144:147]
  ds_read_b64_tr_b16 a[230:231], v7 offset:61440
  v_cvt_pk_bf16_f32 v117, v106, v107
  v_mfma_f32_16x16x32_bf16 v[148:151], a[212:215], v[112:115], v[148:151]
  ds_read_b128 a[184:187], v4 offset:61440
  v_fma_f32 v109, v109, s40, v21
  v_mfma_f32_16x16x32_bf16 v[152:155], a[216:219], v[112:115], v[152:155]
  v_exp_f32 v109, v109
  v_mfma_f32_16x16x32_bf16 v[156:159], a[220:223], v[112:115], v[156:159]
  ds_read_b64_tr_b16 a[232:233], v8 offset:57344
  v_fma_f32 v110, v110, s40, v21
  v_fma_f32 v111, v111, s40, v21
  v_exp_f32 v110, v110
  v_exp_f32 v111, v111
  v_mfma_f32_16x16x32_bf16 v[64:67], v[32:35], v[112:115], v[64:67]
  v_cvt_pk_bf16_f32 v118, v108, v109
  v_cvt_pk_bf16_f32 v119, v110, v111
  v_mfma_f32_16x16x32_bf16 v[104:107], a[128:131], a[48:51], 0
  ds_read_b64_tr_b16 a[234:235], v8 offset:61440
  v_fma_f32 v96, v96, s40, v22
  v_mfma_f32_16x16x32_bf16 v[104:107], a[132:135], a[52:55], v[104:107]
  ds_read_b128 a[172:175], v5 offset:57344
  v_fma_f32 v97, v97, s40, v22
  v_mfma_f32_16x16x32_bf16 v[104:107], a[136:139], a[56:59], v[104:107]
  ds_read_b64_tr_b16 a[236:237], v9 offset:57344
  ds_read_b64_tr_b16 a[238:239], v9 offset:61440
  v_mfma_f32_16x16x32_bf16 v[104:107], a[140:143], a[60:63], v[104:107]
  v_exp_f32 v96, v96
  v_mfma_f32_16x16x32_bf16 v[108:111], a[156:159], a[60:63], 0
  v_exp_f32 v97, v97
  v_mfma_f32_16x16x32_bf16 v[108:111], a[152:155], a[56:59], v[108:111]
  v_fma_f32 v98, v98, s40, v22
  v_fma_f32 v99, v99, s40, v22
  v_mfma_f32_16x16x32_bf16 v[108:111], a[148:151], a[52:55], v[108:111]
  v_exp_f32 v98, v98
  v_mfma_f32_16x16x32_bf16 v[108:111], a[144:147], a[48:51], v[108:111]
  v_exp_f32 v99, v99
  v_mfma_f32_16x16x32_bf16 v[160:163], a[192:195], v[116:119], v[160:163]
  ds_read_b128 a[188:191], v5 offset:61440
  ds_read_b64_tr_b16 a[240:241], v10 offset:57344
  v_mfma_f32_16x16x32_bf16 v[164:167], a[196:199], v[116:119], v[164:167]
  v_cvt_pk_bf16_f32 v112, v96, v97
  v_fma_f32 v100, v100, s40, v22
  v_mfma_f32_16x16x32_bf16 v[168:171], a[200:203], v[116:119], v[168:171]
  ds_read_b64_tr_b16 a[242:243], v10 offset:61440
  ds_read_b64_tr_b16 a[244:245], v11 offset:57344
  v_mfma_f32_16x16x32_bf16 v[172:175], a[204:207], v[116:119], v[172:175]
  v_exp_f32 v100, v100
  v_mfma_f32_16x16x32_bf16 v[176:179], a[208:211], v[116:119], v[176:179]
  v_cvt_pk_bf16_f32 v113, v98, v99
  v_fma_f32 v101, v101, s40, v22
  v_mfma_f32_16x16x32_bf16 v[180:183], a[212:215], v[116:119], v[180:183]
  v_exp_f32 v101, v101
  v_mfma_f32_16x16x32_bf16 v[184:187], a[216:219], v[116:119], v[184:187]
  v_fma_f32 v102, v102, s40, v22
  v_fma_f32 v103, v103, s40, v22
  v_mfma_f32_16x16x32_bf16 v[188:191], a[220:223], v[116:119], v[188:191]
  ds_read_b64_tr_b16 a[246:247], v11 offset:61440
  v_exp_f32 v102, v102
  v_exp_f32 v103, v103
  v_mfma_f32_16x16x32_bf16 v[68:71], v[32:35], v[116:119], v[68:71]
  v_cvt_pk_bf16_f32 v114, v100, v101
  v_cvt_pk_bf16_f32 v115, v102, v103
  s_waitcnt lgkmcnt(4)
  v_mfma_f32_16x16x32_bf16 v[96:99], a[160:163], a[0:3], 0
  ds_read_b64_tr_b16 a[248:249], v12 offset:57344
  v_fma_f32 v104, v104, s40, v23
  v_mfma_f32_16x16x32_bf16 v[96:99], a[164:167], a[4:7], v[96:99]
  ds_read_b64_tr_b16 a[250:251], v12 offset:61440
  v_fma_f32 v105, v105, s40, v23
  v_mfma_f32_16x16x32_bf16 v[96:99], a[168:171], a[8:11], v[96:99]
  v_exp_f32 v104, v104
  v_mfma_f32_16x16x32_bf16 v[96:99], a[172:175], a[12:15], v[96:99]
  v_exp_f32 v105, v105
  v_mfma_f32_16x16x32_bf16 v[100:103], a[188:191], a[12:15], 0
  v_fma_f32 v106, v106, s40, v23
  v_fma_f32 v107, v107, s40, v23
  v_mfma_f32_16x16x32_bf16 v[100:103], a[184:187], a[8:11], v[100:103]
  ds_read_b64_tr_b16 a[252:253], v13 offset:57344
  ds_read_b64_tr_b16 a[254:255], v13 offset:61440
  v_mfma_f32_16x16x32_bf16 v[100:103], a[180:183], a[4:7], v[100:103]
  v_exp_f32 v106, v106
  v_mfma_f32_16x16x32_bf16 v[100:103], a[176:179], a[0:3], v[100:103]
  v_exp_f32 v107, v107
  v_mfma_f32_16x16x32_bf16 v[192:195], a[192:195], v[112:115], v[192:195]
  v_cvt_pk_bf16_f32 v116, v104, v105
  v_fma_f32 v108, v108, s40, v23
  v_mfma_f32_16x16x32_bf16 v[196:199], a[196:199], v[112:115], v[196:199]
  v_exp_f32 v108, v108
  v_mfma_f32_16x16x32_bf16 v[200:203], a[200:203], v[112:115], v[200:203]
  v_cvt_pk_bf16_f32 v117, v106, v107
  v_fma_f32 v109, v109, s40, v23
  v_mfma_f32_16x16x32_bf16 v[204:207], a[204:207], v[112:115], v[204:207]
  v_exp_f32 v109, v109
  v_mfma_f32_16x16x32_bf16 v[208:211], a[208:211], v[112:115], v[208:211]
  v_fma_f32 v110, v110, s40, v23
  v_fma_f32 v111, v111, s40, v23
  v_mfma_f32_16x16x32_bf16 v[212:215], a[212:215], v[112:115], v[212:215]
  v_exp_f32 v110, v110
  v_mfma_f32_16x16x32_bf16 v[216:219], a[216:219], v[112:115], v[216:219]
  v_exp_f32 v111, v111
  v_mfma_f32_16x16x32_bf16 v[220:223], a[220:223], v[112:115], v[220:223]
  v_cvt_pk_bf16_f32 v118, v108, v109
  v_cvt_pk_bf16_f32 v119, v110, v111
  v_mfma_f32_16x16x32_bf16 v[72:75], v[32:35], v[112:115], v[72:75]
  v_fma_f32 v96, v96, s40, v20
  v_fma_f32 v97, v97, s40, v20
  v_mfma_f32_16x16x32_bf16 v[104:107], a[160:163], a[16:19], 0
  v_exp_f32 v96, v96
  v_mfma_f32_16x16x32_bf16 v[104:107], a[164:167], a[20:23], v[104:107]
  v_exp_f32 v97, v97
  v_mfma_f32_16x16x32_bf16 v[104:107], a[168:171], a[24:27], v[104:107]
  v_fma_f32 v98, v98, s40, v20
  v_fma_f32 v99, v99, s40, v20
  v_mfma_f32_16x16x32_bf16 v[104:107], a[172:175], a[28:31], v[104:107]
  v_exp_f32 v98, v98
  v_mfma_f32_16x16x32_bf16 v[108:111], a[188:191], a[28:31], 0
  ds_read_b128 a[128:131], v2 offset:0
  s_add_u32 s45, s45, 8192
  v_mfma_f32_16x16x32_bf16 v[108:111], a[184:187], a[24:27], v[108:111]
  v_exp_f32 v99, v99
  v_mfma_f32_16x16x32_bf16 v[108:111], a[180:183], a[20:23], v[108:111]
  v_cvt_pk_bf16_f32 v112, v96, v97
  v_fma_f32 v100, v100, s40, v20
  v_mfma_f32_16x16x32_bf16 v[108:111], a[176:179], a[16:19], v[108:111]
  v_exp_f32 v100, v100
  v_mfma_f32_16x16x32_bf16 v[224:227], a[192:195], v[116:119], v[224:227]
  v_cvt_pk_bf16_f32 v113, v98, v99
  v_fma_f32 v101, v101, s40, v20
  v_mfma_f32_16x16x32_bf16 v[228:231], a[196:199], v[116:119], v[228:231]
  v_exp_f32 v101, v101
  v_mfma_f32_16x16x32_bf16 v[232:235], a[200:203], v[116:119], v[232:235]
  ds_read_b128 a[144:147], v2 offset:4096
  v_fma_f32 v102, v102, s40, v20
  v_mfma_f32_16x16x32_bf16 v[236:239], a[204:207], v[116:119], v[236:239]
  s_add_u32 m0, s44, 49152
  v_fma_f32 v103, v103, s40, v20
  v_mfma_f32_16x16x32_bf16 v[240:243], a[208:211], v[116:119], v[240:243]
  v_exp_f32 v102, v102
  v_mfma_f32_16x16x32_bf16 v[244:247], a[212:215], v[116:119], v[244:247]
  v_exp_f32 v103, v103
  v_mfma_f32_16x16x32_bf16 v[248:251], a[216:219], v[116:119], v[248:251]
  v_cvt_pk_bf16_f32 v114, v100, v101
  v_cvt_pk_bf16_f32 v115, v102, v103
  v_mfma_f32_16x16x32_bf16 v[252:255], a[220:223], v[116:119], v[252:255]
  ds_read_b128 a[132:135], v3 offset:0
  v_fma_f32 v104, v104, s40, v21
  v_mfma_f32_16x16x32_bf16 v[76:79], v[32:35], v[116:119], v[76:79]
  ds_read_b128 a[148:151], v3 offset:4096
  v_fma_f32 v105, v105, s40, v21
  v_mfma_f32_16x16x32_bf16 v[96:99], a[160:163], a[32:35], 0
  buffer_load_dwordx4 v14, s[20:23], s45 offen offset:0 lds
  buffer_load_dwordx4 v15, s[20:23], s45 offen offset:1024 lds
  buffer_load_dwordx4 v16, s[20:23], s45 offen offset:2048 lds
  buffer_load_dwordx4 v17, s[20:23], s45 offen offset:3072 lds
  v_mfma_f32_16x16x32_bf16 v[96:99], a[164:167], a[36:39], v[96:99]
  v_exp_f32 v104, v104
  v_mfma_f32_16x16x32_bf16 v[96:99], a[168:171], a[40:43], v[96:99]
  v_exp_f32 v105, v105
  v_mfma_f32_16x16x32_bf16 v[96:99], a[172:175], a[44:47], v[96:99]
  ds_read_b64_tr_b16 a[192:193], v6 offset:0
  v_fma_f32 v106, v106, s40, v21
  v_mfma_f32_16x16x32_bf16 v[100:103], a[188:191], a[44:47], 0
  ds_read_b64_tr_b16 a[194:195], v6 offset:4096
  v_fma_f32 v107, v107, s40, v21
  v_mfma_f32_16x16x32_bf16 v[100:103], a[184:187], a[40:43], v[100:103]
  v_exp_f32 v106, v106
  v_mfma_f32_16x16x32_bf16 v[100:103], a[180:183], a[36:39], v[100:103]
  buffer_store_dwordx4 a[120:123], v19, s[24:27], s91 offen offset:2048 sc0 sc1
  buffer_store_dwordx4 a[124:127], v19, s[24:27], s91 offen offset:3072 sc0 sc1
  v_mfma_f32_16x16x32_bf16 v[100:103], a[176:179], a[32:35], v[100:103]
  ds_read_b128 a[136:139], v4 offset:0
  s_waitcnt lgkmcnt(7)
  v_mfma_f32_16x16x32_bf16 v[128:131], a[224:227], v[112:115], v[128:131]
  v_exp_f32 v107, v107
  v_mfma_f32_16x16x32_bf16 v[132:135], a[228:231], v[112:115], v[132:135]
  v_cvt_pk_bf16_f32 v116, v104, v105
  v_fma_f32 v108, v108, s40, v21
  v_mfma_f32_16x16x32_bf16 v[136:139], a[232:235], v[112:115], v[136:139]
  ds_read_b64_tr_b16 a[196:197], v7 offset:0
  ds_read_b64_tr_b16 a[198:199], v7 offset:4096
  v_mfma_f32_16x16x32_bf16 v[140:143], a[236:239], v[112:115], v[140:143]
  v_exp_f32 v108, v108
  v_mfma_f32_16x16x32_bf16 v[144:147], a[240:243], v[112:115], v[144:147]
  v_cvt_pk_bf16_f32 v117, v106, v107
  v_fma_f32 v109, v109, s40, v21
  v_mfma_f32_16x16x32_bf16 v[148:151], a[244:247], v[112:115], v[148:151]
  v_exp_f32 v109, v109
  v_mfma_f32_16x16x32_bf16 v[152:155], a[248:251], v[112:115], v[152:155]
  v_fma_f32 v110, v110, s40, v21
  v_fma_f32 v111, v111, s40, v21
  v_mfma_f32_16x16x32_bf16 v[156:159], a[252:255], v[112:115], v[156:159]
  ds_read_b128 a[152:155], v4 offset:4096
  ds_read_b64_tr_b16 a[200:201], v8 offset:0
  v_exp_f32 v110, v110
  v_exp_f32 v111, v111
  v_mfma_f32_16x16x32_bf16 v[64:67], v[32:35], v[112:115], v[64:67]
  v_cvt_pk_bf16_f32 v118, v108, v109
  v_cvt_pk_bf16_f32 v119, v110, v111
  v_mfma_f32_16x16x32_bf16 v[104:107], a[160:163], a[48:51], 0
  ds_read_b64_tr_b16 a[202:203], v8 offset:4096
  v_fma_f32 v96, v96, s40, v22
  v_mfma_f32_16x16x32_bf16 v[104:107], a[164:167], a[52:55], v[104:107]
  ds_read_b128 a[140:143], v5 offset:0
  v_fma_f32 v97, v97, s40, v22
  v_mfma_f32_16x16x32_bf16 v[104:107], a[168:171], a[56:59], v[104:107]
  ds_read_b64_tr_b16 a[204:205], v9 offset:0
  s_waitcnt vmcnt(36)
  v_mfma_f32_16x16x32_bf16 v[104:107], a[172:175], a[60:63], v[104:107]
  v_exp_f32 v96, v96
  v_mfma_f32_16x16x32_bf16 v[108:111], a[188:191], a[60:63], 0
  ds_read_b64_tr_b16 a[206:207], v9 offset:4096
  ds_read_b128 a[32:35], v52 offset:0
  v_mfma_f32_16x16x32_bf16 v[108:111], a[184:187], a[56:59], v[108:111]
  ds_read_b128 a[36:39], v53 offset:0
  s_waitcnt vmcnt(30)
  s_add_u32 s88, s50, 0
  v_rcp_f32 v24, v64
  v_cmp_ngt_f32 s[54:55], s42, v64
  v_pk_mul_f32 v[128:129], v[128:129], v[24:25] op_sel_hi:[1,0]
  v_pk_mul_f32 v[130:131], v[130:131], v[24:25] op_sel_hi:[1,0]
  v_pk_mul_f32 v[132:133], v[132:133], v[24:25] op_sel_hi:[1,0]
  v_pk_mul_f32 v[134:135], v[134:135], v[24:25] op_sel_hi:[1,0]
  v_pk_mul_f32 v[136:137], v[136:137], v[24:25] op_sel_hi:[1,0]
  v_pk_mul_f32 v[138:139], v[138:139], v[24:25] op_sel_hi:[1,0]
  v_pk_mul_f32 v[140:141], v[140:141], v[24:25] op_sel_hi:[1,0]
  v_pk_mul_f32 v[142:143], v[142:143], v[24:25] op_sel_hi:[1,0]
  v_pk_mul_f32 v[144:145], v[144:145], v[24:25] op_sel_hi:[1,0]
  v_pk_mul_f32 v[146:147], v[146:147], v[24:25] op_sel_hi:[1,0]
  v_pk_mul_f32 v[148:149], v[148:149], v[24:25] op_sel_hi:[1,0]
  v_pk_mul_f32 v[150:151], v[150:151], v[24:25] op_sel_hi:[1,0]
  v_pk_mul_f32 v[152:153], v[152:153], v[24:25] op_sel_hi:[1,0]
  v_pk_mul_f32 v[154:155], v[154:155], v[24:25] op_sel_hi:[1,0]
  v_pk_mul_f32 v[156:157], v[156:157], v[24:25] op_sel_hi:[1,0]
  v_pk_mul_f32 v[158:159], v[158:159], v[24:25] op_sel_hi:[1,0]
  v_mfma_f32_16x16x32_bf16 v[108:111], a[180:183], a[52:55], v[108:111]
  ds_read_b128 a[40:43], v52 offset:2048
  ds_read_b128 a[44:47], v53 offset:2048
  v_cvt_pk_bf16_f32 v128, v128, v129
  v_cvt_pk_bf16_f32 v129, v130, v131
  v_cvt_pk_bf16_f32 v130, v132, v133
  v_cvt_pk_bf16_f32 v131, v134, v135
  v_cvt_pk_bf16_f32 v132, v136, v137
  v_cvt_pk_bf16_f32 v133, v138, v139
  v_cvt_pk_bf16_f32 v134, v140, v141
  v_mfma_f32_16x16x32_bf16 v[108:111], a[176:179], a[48:51], v[108:111]
  ds_read_b128 a[156:159], v5 offset:4096
  ds_read_b64_tr_b16 a[208:209], v10 offset:0
  v_cvt_pk_bf16_f32 v135, v142, v143
  v_cvt_pk_bf16_f32 v136, v144, v145
  v_cvt_pk_bf16_f32 v137, v146, v147
  v_cvt_pk_bf16_f32 v138, v148, v149
  v_cvt_pk_bf16_f32 v139, v150, v151
  v_cvt_pk_bf16_f32 v140, v152, v153
  v_cvt_pk_bf16_f32 v141, v154, v155
  v_mfma_f32_16x16x32_bf16 v[160:163], a[224:227], v[116:119], v[160:163]
  s_waitcnt vmcnt(24)
  ds_read_b128 a[48:51], v52 offset:4096
  v_cvt_pk_bf16_f32 v142, v156, v157
  v_cvt_pk_bf16_f32 v143, v158, v159
  v_mfma_f32_16x16x32_bf16 v[164:167], a[228:231], v[116:119], v[164:167]
  ds_read_b128 a[52:55], v53 offset:4096
  s_waitcnt vmcnt(18)
  v_mfma_f32_16x16x32_bf16 v[168:171], a[232:235], v[116:119], v[168:171]
  ds_read_b64_tr_b16 a[210:211], v10 offset:4096
  ds_read_b128 a[56:59], v52 offset:6144
  v_mfma_f32_16x16x32_bf16 v[172:175], a[236:239], v[116:119], v[172:175]
  ds_read_b128 a[60:63], v53 offset:6144
  v_accvgpr_mov_b32 a0, a64
  v_mfma_f32_16x16x32_bf16 v[176:179], a[240:243], v[116:119], v[176:179]
  v_accvgpr_mov_b32 a1, a65
  v_accvgpr_mov_b32 a2, a66
  v_mfma_f32_16x16x32_bf16 v[180:183], a[244:247], v[116:119], v[180:183]
  ds_read_b64_tr_b16 a[212:213], v11 offset:0
  v_exp_f32 v97, v97
  v_fma_f32 v98, v98, s40, v22
  v_fma_f32 v99, v99, s40, v22
  v_exp_f32 v98, v98
  v_exp_f32 v99, v99
  v_mfma_f32_16x16x32_bf16 v[184:187], a[248:251], v[116:119], v[184:187]
  v_accvgpr_mov_b32 a3, a67
  v_accvgpr_mov_b32 a4, a68
  v_accvgpr_mov_b32 a5, a69
  v_accvgpr_mov_b32 a6, a70
  v_accvgpr_mov_b32 a7, a71
  v_accvgpr_mov_b32 a8, a72
  v_accvgpr_mov_b32 a9, a73
  v_accvgpr_mov_b32 a10, a74
  v_accvgpr_mov_b32 a11, a75
  v_accvgpr_mov_b32 a12, a76
  v_accvgpr_mov_b32 a13, a77
  v_accvgpr_mov_b32 a14, a78
  v_accvgpr_mov_b32 a15, a79
  v_cvt_pk_bf16_f32 v112, v96, v97
  v_fma_f32 v100, v100, s40, v22
  v_exp_f32 v100, v100
  v_mfma_f32_16x16x32_bf16 v[188:191], a[252:255], v[116:119], v[188:191]
  ds_read_b64_tr_b16 a[214:215], v11 offset:4096
  v_cvt_pk_bf16_f32 v113, v98, v99
  v_fma_f32 v101, v101, s40, v22
  v_exp_f32 v101, v101
  v_fma_f32 v102, v102, s40, v22
  v_fma_f32 v103, v103, s40, v22
  v_exp_f32 v102, v102
  v_exp_f32 v103, v103
  v_mfma_f32_16x16x32_bf16 v[68:71], v[32:35], v[116:119], v[68:71]
  v_cvt_pk_bf16_f32 v114, v100, v101
  v_cvt_pk_bf16_f32 v115, v102, v103
  s_waitcnt lgkmcnt(8)
  v_mfma_f32_16x16x32_bf16 v[96:99], a[128:131], a[0:3], 0
  ds_read_b64_tr_b16 a[216:217], v12 offset:0
  ds_read_b64_tr_b16 a[218:219], v12 offset:4096
  v_mfma_f32_16x16x32_bf16 v[96:99], a[132:135], a[4:7], v[96:99]
  ds_read_b64_tr_b16 a[220:221], v13 offset:0
  v_fma_f32 v104, v104, s40, v23
  v_mfma_f32_16x16x32_bf16 v[96:99], a[136:139], a[8:11], v[96:99]
  ds_write_b64 v56, v[128:129] offset:0
  v_mfma_f32_16x16x32_bf16 v[96:99], a[140:143], a[12:15], v[96:99]
  ds_write_b64 v56, v[130:131] offset:32
  v_mfma_f32_16x16x32_bf16 v[100:103], a[156:159], a[12:15], 0
  ds_write_b64 v56, v[132:133] offset:64
  v_mfma_f32_16x16x32_bf16 v[100:103], a[152:155], a[8:11], v[100:103]
  ds_write_b64 v56, v[134:135] offset:96
  s_add_u32 s89, s50, 4096
  v_rcp_f32 v26, v68
  v_cmp_ngt_f32 s[56:57], s42, v68
  v_pk_mul_f32 v[160:161], v[160:161], v[26:27] op_sel_hi:[1,0]
  v_pk_mul_f32 v[162:163], v[162:163], v[26:27] op_sel_hi:[1,0]
  v_pk_mul_f32 v[164:165], v[164:165], v[26:27] op_sel_hi:[1,0]
  v_pk_mul_f32 v[166:167], v[166:167], v[26:27] op_sel_hi:[1,0]
  v_pk_mul_f32 v[168:169], v[168:169], v[26:27] op_sel_hi:[1,0]
  v_pk_mul_f32 v[170:171], v[170:171], v[26:27] op_sel_hi:[1,0]
  v_pk_mul_f32 v[172:173], v[172:173], v[26:27] op_sel_hi:[1,0]
  v_pk_mul_f32 v[174:175], v[174:175], v[26:27] op_sel_hi:[1,0]
  v_pk_mul_f32 v[176:177], v[176:177], v[26:27] op_sel_hi:[1,0]
  v_pk_mul_f32 v[178:179], v[178:179], v[26:27] op_sel_hi:[1,0]
  v_pk_mul_f32 v[180:181], v[180:181], v[26:27] op_sel_hi:[1,0]
  v_pk_mul_f32 v[182:183], v[182:183], v[26:27] op_sel_hi:[1,0]
  v_pk_mul_f32 v[184:185], v[184:185], v[26:27] op_sel_hi:[1,0]
  v_pk_mul_f32 v[186:187], v[186:187], v[26:27] op_sel_hi:[1,0]
  v_pk_mul_f32 v[188:189], v[188:189], v[26:27] op_sel_hi:[1,0]
  v_pk_mul_f32 v[190:191], v[190:191], v[26:27] op_sel_hi:[1,0]
  v_mfma_f32_16x16x32_bf16 v[100:103], a[148:151], a[4:7], v[100:103]
  ds_write_b64 v56, v[136:137] offset:128
  v_cvt_pk_bf16_f32 v160, v160, v161
  v_cvt_pk_bf16_f32 v161, v162, v163
  v_cvt_pk_bf16_f32 v162, v164, v165
  v_cvt_pk_bf16_f32 v163, v166, v167
  v_cvt_pk_bf16_f32 v164, v168, v169
  v_cvt_pk_bf16_f32 v165, v170, v171
  v_mfma_f32_16x16x32_bf16 v[100:103], a[144:147], a[0:3], v[100:103]
  ds_write_b64 v56, v[138:139] offset:160
  v_cvt_pk_bf16_f32 v166, v172, v173
  v_cvt_pk_bf16_f32 v167, v174, v175
  v_cvt_pk_bf16_f32 v168, v176, v177
  v_cvt_pk_bf16_f32 v169, v178, v179
  v_cvt_pk_bf16_f32 v170, v180, v181
  v_cvt_pk_bf16_f32 v171, v182, v183
  v_mfma_f32_16x16x32_bf16 v[192:195], a[224:227], v[112:115], v[192:195]
  ds_read_b64_tr_b16 a[222:223], v13 offset:4096
  ds_write_b64 v56, v[140:141] offset:192
  v_cvt_pk_bf16_f32 v172, v184, v185
  v_cvt_pk_bf16_f32 v173, v186, v187
  v_cvt_pk_bf16_f32 v174, v188, v189
  v_cvt_pk_bf16_f32 v175, v190, v191
  v_mfma_f32_16x16x32_bf16 v[196:199], a[228:231], v[112:115], v[196:199]
  ds_write_b64 v56, v[142:143] offset:224
  ds_read_b128 v[80:83], v57 offset:0
  ds_read_b128 v[84:87], v57 offset:1088
  ds_read_b128 v[88:91], v57 offset:2176
  ds_read_b128 v[92:95], v57 offset:3264
  v_mfma_f32_16x16x32_bf16 v[200:203], a[232:235], v[112:115], v[200:203]
  v_fma_f32 v105, v105, s40, v23
  v_exp_f32 v104, v104
  v_mfma_f32_16x16x32_bf16 v[204:207], a[236:239], v[112:115], v[204:207]
  v_exp_f32 v105, v105
  v_mfma_f32_16x16x32_bf16 v[208:211], a[240:243], v[112:115], v[208:211]
  v_fma_f32 v106, v106, s40, v23
  v_fma_f32 v107, v107, s40, v23
  v_mfma_f32_16x16x32_bf16 v[212:215], a[244:247], v[112:115], v[212:215]
  v_exp_f32 v106, v106
  v_exp_f32 v107, v107
  v_mfma_f32_16x16x32_bf16 v[216:219], a[248:251], v[112:115], v[216:219]
  v_cvt_pk_bf16_f32 v116, v104, v105
  v_fma_f32 v108, v108, s40, v23
  v_exp_f32 v108, v108
  v_mfma_f32_16x16x32_bf16 v[220:223], a[252:255], v[112:115], v[220:223]
  v_cvt_pk_bf16_f32 v117, v106, v107
  v_fma_f32 v109, v109, s40, v23
  v_exp_f32 v109, v109
  v_fma_f32 v110, v110, s40, v23
  v_fma_f32 v111, v111, s40, v23
  v_exp_f32 v110, v110
  v_exp_f32 v111, v111
  v_mfma_f32_16x16x32_bf16 v[72:75], v[32:35], v[112:115], v[72:75]
  v_accvgpr_mov_b32 a16, a80
  v_accvgpr_mov_b32 a17, a81
  v_accvgpr_mov_b32 a18, a82
  v_accvgpr_mov_b32 a19, a83
  v_accvgpr_mov_b32 a20, a84
  v_accvgpr_mov_b32 a21, a85
  v_accvgpr_mov_b32 a22, a86
  v_accvgpr_mov_b32 a23, a87
  v_accvgpr_mov_b32 a24, a88
  v_accvgpr_mov_b32 a25, a89
  v_accvgpr_mov_b32 a26, a90
  v_accvgpr_mov_b32 a27, a91
  v_accvgpr_mov_b32 a28, a92
  v_accvgpr_mov_b32 a29, a93
  v_accvgpr_mov_b32 a30, a94
  v_accvgpr_mov_b32 a31, a95
  v_cvt_pk_bf16_f32 v118, v108, v109
  v_cvt_pk_bf16_f32 v119, v110, v111
  s_sub_u32 s62, s62, 1
  s_cbranch_scc0 L_loop
  s_mov_b32 s52, s50
  s_mov_b32 s53, s51
  s_mov_b32 s50, s48
  s_mov_b32 s51, s49
  v_mfma_f32_16x16x32_bf16 v[224:227], a[224:227], v[116:119], v[224:227]
  s_waitcnt lgkmcnt(0)
  buffer_store_dwordx4 v[80:83], v19, s[24:27], s88 offen offset:0 sc0 sc1
  buffer_store_dwordx4 v[84:87], v19, s[24:27], s88 offen offset:1024 sc0 sc1
  buffer_store_dwordx4 v[88:91], v19, s[24:27], s88 offen offset:2048 sc0 sc1
  buffer_store_dwordx4 v[92:95], v19, s[24:27], s88 offen offset:3072 sc0 sc1
  v_mfma_f32_16x16x32_bf16 v[228:231], a[228:231], v[116:119], v[228:231]
  ds_write_b64 v56, v[160:161] offset:0
  ds_write_b64 v56, v[162:163] offset:32
  v_mfma_f32_16x16x32_bf16 v[232:235], a[232:235], v[116:119], v[232:235]
  ds_write_b64 v56, v[164:165] offset:64
  ds_write_b64 v56, v[166:167] offset:96
  v_mfma_f32_16x16x32_bf16 v[236:239], a[236:239], v[116:119], v[236:239]
  ds_write_b64 v56, v[168:169] offset:128
  ds_write_b64 v56, v[170:171] offset:160
  v_mfma_f32_16x16x32_bf16 v[240:243], a[240:243], v[116:119], v[240:243]
  ds_write_b64 v56, v[172:173] offset:192
  ds_write_b64 v56, v[174:175] offset:224
  v_mfma_f32_16x16x32_bf16 v[244:247], a[244:247], v[116:119], v[244:247]
  ds_read_b128 v[120:123], v57 offset:0
  ds_read_b128 v[124:127], v57 offset:1088
  ds_read_b128 v[36:39], v57 offset:2176
  ds_read_b128 v[40:43], v57 offset:3264
  v_rcp_f32 v28, v72
  v_mfma_f32_16x16x32_bf16 v[248:251], a[248:251], v[116:119], v[248:251]
  s_add_u32 s90, s52, 8192
  v_cmp_ngt_f32 s[58:59], s42, v72
  v_pk_mul_f32 v[192:193], v[192:193], v[28:29] op_sel_hi:[1,0]
  v_pk_mul_f32 v[194:195], v[194:195], v[28:29] op_sel_hi:[1,0]
  v_pk_mul_f32 v[196:197], v[196:197], v[28:29] op_sel_hi:[1,0]
  v_pk_mul_f32 v[198:199], v[198:199], v[28:29] op_sel_hi:[1,0]
  v_pk_mul_f32 v[200:201], v[200:201], v[28:29] op_sel_hi:[1,0]
  v_pk_mul_f32 v[202:203], v[202:203], v[28:29] op_sel_hi:[1,0]
  v_pk_mul_f32 v[204:205], v[204:205], v[28:29] op_sel_hi:[1,0]
  v_pk_mul_f32 v[206:207], v[206:207], v[28:29] op_sel_hi:[1,0]
  v_pk_mul_f32 v[208:209], v[208:209], v[28:29] op_sel_hi:[1,0]
  v_pk_mul_f32 v[210:211], v[210:211], v[28:29] op_sel_hi:[1,0]
  v_pk_mul_f32 v[212:213], v[212:213], v[28:29] op_sel_hi:[1,0]
  v_pk_mul_f32 v[214:215], v[214:215], v[28:29] op_sel_hi:[1,0]
  v_pk_mul_f32 v[216:217], v[216:217], v[28:29] op_sel_hi:[1,0]
  v_pk_mul_f32 v[218:219], v[218:219], v[28:29] op_sel_hi:[1,0]
  v_pk_mul_f32 v[220:221], v[220:221], v[28:29] op_sel_hi:[1,0]
  v_pk_mul_f32 v[222:223], v[222:223], v[28:29] op_sel_hi:[1,0]
  v_mfma_f32_16x16x32_bf16 v[252:255], a[252:255], v[116:119], v[252:255]
  v_cvt_pk_bf16_f32 v192, v192, v193
  v_cvt_pk_bf16_f32 v193, v194, v195
  v_cvt_pk_bf16_f32 v194, v196, v197
  v_cvt_pk_bf16_f32 v195, v198, v199
  v_cvt_pk_bf16_f32 v196, v200, v201
  v_cvt_pk_bf16_f32 v197, v202, v203
  v_mfma_f32_16x16x32_bf16 v[76:79], v[32:35], v[116:119], v[76:79]
  s_waitcnt lgkmcnt(0)
  buffer_store_dwordx4 v[120:123], v19, s[24:27], s89 offen offset:0 sc0 sc1
  buffer_store_dwordx4 v[124:127], v19, s[24:27], s89 offen offset:1024 sc0 sc1
  buffer_store_dwordx4 v[36:39], v19, s[24:27], s89 offen offset:2048 sc0 sc1
  buffer_store_dwordx4 v[40:43], v19, s[24:27], s89 offen offset:3072 sc0 sc1
  ds_write_b64 v56, v[192:193] offset:0
  ds_write_b64 v56, v[194:195] offset:32
  ds_write_b64 v56, v[196:197] offset:64
  v_cvt_pk_bf16_f32 v198, v204, v205
  v_cvt_pk_bf16_f32 v199, v206, v207
  v_cvt_pk_bf16_f32 v200, v208, v209
  v_cvt_pk_bf16_f32 v201, v210, v211
  v_cvt_pk_bf16_f32 v202, v212, v213
  v_cvt_pk_bf16_f32 v203, v214, v215
  v_cvt_pk_bf16_f32 v204, v216, v217
  v_cvt_pk_bf16_f32 v205, v218, v219
  v_cvt_pk_bf16_f32 v206, v220, v221
  v_cvt_pk_bf16_f32 v207, v222, v223
  ds_write_b64 v56, v[198:199] offset:96
  ds_write_b64 v56, v[200:201] offset:128
  ds_write_b64 v56, v[202:203] offset:160
  ds_write_b64 v56, v[204:205] offset:192
  ds_write_b64 v56, v[206:207] offset:224
  ds_read_b128 a[96:99], v57 offset:0
  ds_read_b128 a[100:103], v57 offset:1088
  ds_read_b128 a[104:107], v57 offset:2176
  ds_read_b128 a[108:111], v57 offset:3264
  v_rcp_f32 v30, v76
  v_cmp_ngt_f32 s[60:61], s42, v76
  s_add_u32 s91, s52, 12288
  v_pk_mul_f32 v[224:225], v[224:225], v[30:31] op_sel_hi:[1,0]
  v_pk_mul_f32 v[226:227], v[226:227], v[30:31] op_sel_hi:[1,0]
  v_pk_mul_f32 v[228:229], v[228:229], v[30:31] op_sel_hi:[1,0]
  v_pk_mul_f32 v[230:231], v[230:231], v[30:31] op_sel_hi:[1,0]
  v_pk_mul_f32 v[232:233], v[232:233], v[30:31] op_sel_hi:[1,0]
  v_pk_mul_f32 v[234:235], v[234:235], v[30:31] op_sel_hi:[1,0]
  v_pk_mul_f32 v[236:237], v[236:237], v[30:31] op_sel_hi:[1,0]
  v_pk_mul_f32 v[238:239], v[238:239], v[30:31] op_sel_hi:[1,0]
  v_pk_mul_f32 v[240:241], v[240:241], v[30:31] op_sel_hi:[1,0]
  v_pk_mul_f32 v[242:243], v[242:243], v[30:31] op_sel_hi:[1,0]
  v_pk_mul_f32 v[244:245], v[244:245], v[30:31] op_sel_hi:[1,0]
  v_pk_mul_f32 v[246:247], v[246:247], v[30:31] op_sel_hi:[1,0]
  v_pk_mul_f32 v[248:249], v[248:249], v[30:31] op_sel_hi:[1,0]
  v_pk_mul_f32 v[250:251], v[250:251], v[30:31] op_sel_hi:[1,0]
  v_pk_mul_f32 v[252:253], v[252:253], v[30:31] op_sel_hi:[1,0]
  v_pk_mul_f32 v[254:255], v[254:255], v[30:31] op_sel_hi:[1,0]
  v_cvt_pk_bf16_f32 v224, v224, v225
  v_cvt_pk_bf16_f32 v225, v226, v227
  v_cvt_pk_bf16_f32 v226, v228, v229
  v_cvt_pk_bf16_f32 v227, v230, v231
  v_cvt_pk_bf16_f32 v228, v232, v233
  v_cvt_pk_bf16_f32 v229, v234, v235
  v_cvt_pk_bf16_f32 v230, v236, v237
  v_cvt_pk_bf16_f32 v231, v238, v239
  v_cvt_pk_bf16_f32 v232, v240, v241
  v_cvt_pk_bf16_f32 v233, v242, v243
  v_cvt_pk_bf16_f32 v234, v244, v245
  v_cvt_pk_bf16_f32 v235, v246, v247
  v_cvt_pk_bf16_f32 v236, v248, v249
  v_cvt_pk_bf16_f32 v237, v250, v251
  v_cvt_pk_bf16_f32 v238, v252, v253
  v_cvt_pk_bf16_f32 v239, v254, v255
  s_waitcnt lgkmcnt(0)
  buffer_store_dwordx4 a[96:99], v19, s[24:27], s90 offen offset:0 sc0 sc1
  buffer_store_dwordx4 a[100:103], v19, s[24:27], s90 offen offset:1024 sc0 sc1
  buffer_store_dwordx4 a[104:107], v19, s[24:27], s90 offen offset:2048 sc0 sc1
  buffer_store_dwordx4 a[108:111], v19, s[24:27], s90 offen offset:3072 sc0 sc1
  ds_write_b64 v56, v[224:225] offset:0
  ds_write_b64 v56, v[226:227] offset:32
  ds_write_b64 v56, v[228:229] offset:64
  ds_write_b64 v56, v[230:231] offset:96
  ds_write_b64 v56, v[232:233] offset:128
  ds_write_b64 v56, v[234:235] offset:160
  ds_write_b64 v56, v[236:237] offset:192
  ds_write_b64 v56, v[238:239] offset:224
  ds_read_b128 a[112:115], v57 offset:0
  ds_read_b128 a[116:119], v57 offset:1088
  ds_read_b128 a[120:123], v57 offset:2176
  ds_read_b128 a[124:127], v57 offset:3264
  s_waitcnt lgkmcnt(0)
  buffer_store_dwordx4 a[112:115], v19, s[24:27], s91 offen offset:0 sc0 sc1
  buffer_store_dwordx4 a[116:119], v19, s[24:27], s91 offen offset:1024 sc0 sc1
  buffer_store_dwordx4 a[120:123], v19, s[24:27], s91 offen offset:2048 sc0 sc1
  buffer_store_dwordx4 a[124:127], v19, s[24:27], s91 offen offset:3072 sc0 sc1
  s_or_b64 s[54:55], s[54:55], s[56:57]
  s_or_b64 s[58:59], s[58:59], s[60:61]
  s_or_b64 s[54:55], s[54:55], s[58:59]
  s_cbranch_scc1 L_slow1
L_ret1:
L_end:
  s_endpgm
L_slow0:
  s_mov_b32 s10, 0
  s_branch L_slow
L_slow1:
  s_mov_b32 s10, 1
L_slow:
  s_waitcnt vmcnt(0) lgkmcnt(0)
  s_mov_b32 s8, m0
  s_mov_b32 s88, 1073741824
  s_mov_b32 s89, 1073741824
  s_mov_b32 s90, 1073741824
  s_mov_b32 s91, 1073741824
  s_mul_i32 s9, s2, 196608
  s_nop 7
  s_nop 7
  s_add_u32 s11, s9, 0
  buffer_store_dwordx4 v[96:99], v19, s[36:39], s11 offen offset:0
  buffer_store_dwordx4 v[100:103], v19, s[36:39], s11 offen offset:1024
  buffer_store_dwordx4 v[104:107], v19, s[36:39], s11 offen offset:2048
  buffer_store_dwordx4 v[108:111], v19, s[36:39], s11 offen offset:3072
  s_add_u32 s11, s9, 4096
  buffer_store_dwordx4 v[112:115], v19, s[36:39], s11 offen offset:0
  buffer_store_dwordx4 v[116:119], v19, s[36:39], s11 offen offset:1024
  buffer_store_dwordx4 v[120:123], v19, s[36:39], s11 offen offset:2048
  buffer_store_dwordx4 v[124:127], v19, s[36:39], s11 offen offset:3072
  s_add_u32 s11, s9, 8192
  buffer_store_dwordx4 v[128:131], v19, s[36:39], s11 offen offset:0
  buffer_store_dwordx4 v[132:135], v19, s[36:39], s11 offen offset:1024
  buffer_store_dwordx4 v[136:139], v19, s[36:39], s11 offen offset:2048
  buffer_store_dwordx4 v[140:143], v19, s[36:39], s11 offen offset:3072
  s_add_u32 s11, s9, 12288
  buffer_store_dwordx4 v[144:147], v19, s[36:39], s11 offen offset:0
  buffer_store_dwordx4 v[148:151], v19, s[36:39], s11 offen offset:1024
  buffer_store_dwordx4 v[152:155], v19, s[36:39], s11 offen offset:2048
  buffer_store_dwordx4 v[156:159], v19, s[36:39], s11 offen offset:3072
  s_add_u32 s11, s9, 65536
  buffer_store_dwordx4 v[160:163], v19, s[36:39], s11 offen offset:0
  buffer_store_dwordx4 v[164:167], v19, s[36:39], s11 offen offset:1024
  buffer_store_dwordx4 v[168:171], v19, s[36:39], s11 offen offset:2048
  buffer_store_dwordx4 v[172:175], v19, s[36:39], s11 offen offset:3072
  s_add_u32 s11, s9, 69632
  buffer_store_dwordx4 v[176:179], v19, s[36:39], s11 offen offset:0
  buffer_store_dwordx4 v[180:183], v19, s[36:39], s11 offen offset:1024
  buffer_store_dwordx4 v[184:187], v19, s[36:39], s11 offen offset:2048
  buffer_store_dwordx4 v[188:191], v19, s[36:39], s11 offen offset:3072
  s_add_u32 s11, s9, 73728
  buffer_store_dwordx4 v[192:195], v19, s[36:39], s11 offen offset:0
  buffer_store_dwordx4 v[196:199], v19, s[36:39], s11 offen offset:1024
  buffer_store_dwordx4 v[200:203], v19, s[36:39], s11 offen offset:2048
  buffer_store_dwordx4 v[204:207], v19, s[36:39], s11 offen offset:3072
  s_add_u32 s11, s9, 77824
  buffer_store_dwordx4 v[208:211], v19, s[36:39], s11 offen offset:0
  buffer_store_dwordx4 v[212:215], v19, s[36:39], s11 offen offset:1024
  buffer_store_dwordx4 v[216:219], v19, s[36:39], s11 offen offset:2048
  buffer_store_dwordx4 v[220:223], v19, s[36:39], s11 offen offset:3072
  s_add_u32 s11, s9, 131072
  buffer_store_dwordx4 v[224:227], v19, s[36:39], s11 offen offset:0
  buffer_store_dwordx4 v[228:231], v19, s[36:39], s11 offen offset:1024
  buffer_store_dwordx4 v[232:235], v19, s[36:39], s11 offen offset:2048
  buffer_store_dwordx4 v[236:239], v19, s[36:39], s11 offen offset:3072
  s_add_u32 s11, s9, 135168
  buffer_store_dwordx4 v[240:243], v19, s[36:39], s11 offen offset:0
  buffer_store_dwordx4 v[244:247], v19, s[36:39], s11 offen offset:1024
  buffer_store_dwordx4 v[248:251], v19, s[36:39], s11 offen offset:2048
  buffer_store_dwordx4 v[252:255], v19, s[36:39], s11 offen offset:3072
  s_waitcnt vmcnt(0)
  v_and_b32 v111, 15, v0
  v_lshrrev_b32 v112, 4, v0
  v_lshlrev_b32 v96, 4, v112
  v_lshl_add_u32 v96, v111, 8, v96
  v_add_u32 v97, 0x1000, v96
  v_lshlrev_b32 v110, 3, v112
  v_lshl_add_u32 v110, v111, 8, v110
  v_add_u32 v113, 0, v112
  v_and_b32 v113, 7, v113
  v_lshlrev_b32 v113, 1, v113
  v_xor_b32 v113, v113, v111
  v_lshlrev_b32 v113, 4, v113
  v_lshl_add_u32 v98, v112, 8, v113
  v_add_u32 v113, 4, v112
  v_and_b32 v113, 7, v113
  v_lshlrev_b32 v113, 1, v113
  v_xor_b32 v113, v113, v111
  v_lshlrev_b32 v113, 4, v113
  v_lshl_add_u32 v99, v112, 8, v113
  v_add_u32 v113, 8, v112
  v_and_b32 v113, 7, v113
  v_lshlrev_b32 v113, 1, v113
  v_xor_b32 v113, v113, v111
  v_lshlrev_b32 v113, 4, v113
  v_lshl_add_u32 v100, v112, 8, v113
  v_add_u32 v113, 12, v112
  v_and_b32 v113, 7, v113
  v_lshlrev_b32 v113, 1, v113
  v_xor_b32 v113, v113, v111
  v_lshlrev_b32 v113, 4, v113
  v_lshl_add_u32 v101, v112, 8, v113
  s_sub_u32 s11, s80, 0x10000
  v_add_u32 v102, s11, v6
  v_add_u32 v103, s11, v7
  v_add_u32 v104, s11, v8
  v_add_u32 v105, s11, v9
  v_add_u32 v106, s11, v10
  v_add_u32 v107, s11, v11
  v_add_u32 v108, s11, v12
  v_add_u32 v109, s11, v13
  s_add_u32 s7, s52, s81
  s_mov_b32 s4, 0
L_sl_g:
  buffer_load_dwordx4 v[128:131], v96, s[16:19], s7 offen offset:0
  buffer_load_dwordx4 v[132:135], v96, s[16:19], s7 offen offset:64
  buffer_load_dwordx4 v[136:139], v96, s[16:19], s7 offen offset:128
  buffer_load_dwordx4 v[140:143], v96, s[16:19], s7 offen offset:192
  v_mov_b32 v220, 0
  v_mov_b32 v221, 0
  v_mov_b32 v222, 0
  v_mov_b32 v223, 0
  v_mov_b32 v224, 0
  v_mov_b32 v225, 0
  v_mov_b32 v226, 0
  v_mov_b32 v227, 0
  v_mov_b32 v228, 0
  v_mov_b32 v229, 0
  v_mov_b32 v230, 0
  v_mov_b32 v231, 0
  v_mov_b32 v232, 0
  v_mov_b32 v233, 0
  v_mov_b32 v234, 0
  v_mov_b32 v235, 0
  v_mov_b32 v236, 0
  v_mov_b32 v237, 0
  v_mov_b32 v238, 0
  v_mov_b32 v239, 0
  v_mov_b32 v240, 0
  v_mov_b32 v241, 0
  v_mov_b32 v242, 0
  v_mov_b32 v243, 0
  v_mov_b32 v244, 0
  v_mov_b32 v245, 0
  v_mov_b32 v246, 0
  v_mov_b32 v247, 0
  v_mov_b32 v248, 0
  v_mov_b32 v249, 0
  v_mov_b32 v250, 0
  v_mov_b32 v251, 0
  v_mov_b32 v252, 0xff7fffff
  v_mov_b32 v253, 0
  s_mov_b32 s6, s53
  s_mov_b32 s5, 0
L_sl_t:
  buffer_load_dwordx4 v[144:147], v96, s[28:31], s6 offen offset:0
  buffer_load_dwordx4 v[148:151], v96, s[28:31], s6 offen offset:64
  buffer_load_dwordx4 v[152:155], v96, s[28:31], s6 offen offset:128
  buffer_load_dwordx4 v[156:159], v96, s[28:31], s6 offen offset:192
  buffer_load_dwordx4 v[160:163], v97, s[28:31], s6 offen offset:0
  buffer_load_dwordx4 v[164:167], v97, s[28:31], s6 offen offset:64
  buffer_load_dwordx4 v[168:171], v97, s[28:31], s6 offen offset:128
  buffer_load_dwordx4 v[172:175], v97, s[28:31], s6 offen offset:192
  s_add_u32 m0, s80, 0
  s_add_u32 s11, s6, 0
  buffer_load_dwordx4 v98, s[32:35], s11 offen offset:0 lds
  buffer_load_dwordx4 v99, s[32:35], s11 offen offset:1024 lds
  buffer_load_dwordx4 v100, s[32:35], s11 offen offset:2048 lds
  buffer_load_dwordx4 v101, s[32:35], s11 offen offset:3072 lds
  s_add_u32 m0, s80, 4096
  s_add_u32 s11, s6, 4096
  buffer_load_dwordx4 v98, s[32:35], s11 offen offset:0 lds
  buffer_load_dwordx4 v99, s[32:35], s11 offen offset:1024 lds
  buffer_load_dwordx4 v100, s[32:35], s11 offen offset:2048 lds
  buffer_load_dwordx4 v101, s[32:35], s11 offen offset:3072 lds
  s_waitcnt vmcnt(0)
  ds_read_b64_tr_b16 v[176:177], v102 offset:0
  ds_read_b64_tr_b16 v[178:179], v102 offset:4096
  ds_read_b64_tr_b16 v[180:181], v103 offset:0
  ds_read_b64_tr_b16 v[182:183], v103 offset:4096
  ds_read_b64_tr_b16 v[184:185], v104 offset:0
  ds_read_b64_tr_b16 v[186:187], v104 offset:4096
  ds_read_b64_tr_b16 v[188:189], v105 offset:0
  ds_read_b64_tr_b16 v[190:191], v105 offset:4096
  ds_read_b64_tr_b16 v[192:193], v106 offset:0
  ds_read_b64_tr_b16 v[194:195], v106 offset:4096
  ds_read_b64_tr_b16 v[196:197], v107 offset:0
  ds_read_b64_tr_b16 v[198:199], v107 offset:4096
  ds_read_b64_tr_b16 v[200:201], v108 offset:0
  ds_read_b64_tr_b16 v[202:203], v108 offset:4096
  ds_read_b64_tr_b16 v[204:205], v109 offset:0
  ds_read_b64_tr_b16 v[206:207], v109 offset:4096
  v_mfma_f32_16x16x32_bf16 v[208:211], v[144:147], v[128:131], 0
  v_mfma_f32_16x16x32_bf16 v[212:215], v[160:163], v[128:131], 0
  v_mfma_f32_16x16x32_bf16 v[208:211], v[148:151], v[132:135], v[208:211]
  v_mfma_f32_16x16x32_bf16 v[212:215], v[164:167], v[132:135], v[212:215]
  v_mfma_f32_16x16x32_bf16 v[208:211], v[152:155], v[136:139], v[208:211]
  v_mfma_f32_16x16x32_bf16 v[212:215], v[168:171], v[136:139], v[212:215]
  v_mfma_f32_16x16x32_bf16 v[208:211], v[156:159], v[140:143], v[208:211]
  v_mfma_f32_16x16x32_bf16 v[212:215], v[172:175], v[140:143], v[212:215]
  s_nop 7
  s_nop 1
  v_mul_f32 v208, s40, v208
  v_mul_f32 v209, s40, v209
  v_mul_f32 v210, s40, v210
  v_mul_f32 v211, s40, v211
  v_mul_f32 v212, s40, v212
  v_mul_f32 v213, s40, v213
  v_mul_f32 v214, s40, v214
  v_mul_f32 v215, s40, v215
  v_max3_f32 v254, v208, v209, v210
  v_max3_f32 v255, v211, v212, v213
  v_max3_f32 v254, v214, v215, v254
  v_max3_f32 v254, v254, v255, v252
  v_mov_b32 v255, v254
  s_nop 1
  v_permlane32_swap_b32 v255, v254
  v_max_f32 v254, v254, v255
  v_mov_b32 v255, v254
  s_nop 1
  v_permlane16_swap_b32 v255, v254
  v_max_f32 v254, v254, v255
  v_sub_f32 v255, v252, v254
  v_exp_f32 v255, v255
  v_mov_b32 v252, v254
  v_sub_f32 v208, v208, v254
  v_sub_f32 v209, v209, v254
  v_sub_f32 v210, v210, v254
  v_sub_f32 v211, v211, v254
  v_sub_f32 v212, v212, v254
  v_sub_f32 v213, v213, v254
  v_sub_f32 v214, v214, v254
  v_sub_f32 v215, v215, v254
  v_exp_f32 v208, v208
  v_exp_f32 v209, v209
  v_exp_f32 v210, v210
  v_exp_f32 v211, v211
  v_exp_f32 v212, v212
  v_exp_f32 v213, v213
  v_exp_f32 v214, v214
  v_exp_f32 v215, v215
  v_mul_f32 v253, v253, v255
  v_mul_f32 v220, v220, v255
  v_mul_f32 v221, v221, v255
  v_mul_f32 v222, v222, v255
  v_mul_f32 v223, v223, v255
  v_mul_f32 v224, v224, v255
  v_mul_f32 v225, v225, v255
  v_mul_f32 v226, v226, v255
  v_mul_f32 v227, v227, v255
  v_mul_f32 v228, v228, v255
  v_mul_f32 v229, v229, v255
  v_mul_f32 v230, v230, v255
  v_mul_f32 v231, v231, v255
  v_mul_f32 v232, v232, v255
  v_mul_f32 v233, v233, v255
  v_mul_f32 v234, v234, v255
  v_mul_f32 v235, v235, v255
  v_mul_f32 v236, v236, v255
  v_mul_f32 v237, v237, v255
  v_mul_f32 v238, v238, v255
  v_mul_f32 v239, v239, v255
  v_mul_f32 v240, v240, v255
  v_mul_f32 v241, v241, v255
  v_mul_f32 v242, v242, v255
  v_mul_f32 v243, v243, v255
  v_mul_f32 v244, v244, v255
  v_mul_f32 v245, v245, v255
  v_mul_f32 v246, v246, v255
  v_mul_f32 v247, v247, v255
  v_mul_f32 v248, v248, v255
  v_mul_f32 v249, v249, v255
  v_mul_f32 v250, v250, v255
  v_mul_f32 v251, v251, v255
  v_cvt_pk_bf16_f32 v216, v208, v209
  v_cvt_pk_bf16_f32 v217, v210, v211
  v_cvt_pk_bf16_f32 v218, v212, v213
  v_cvt_pk_bf16_f32 v219, v214, v215
  v_lshlrev_b32 v254, 16, v216
  v_and_b32 v255, 0xffff0000, v216
  v_add_f32 v253, v253, v254
  v_add_f32 v253, v253, v255
  v_lshlrev_b32 v254, 16, v217
  v_and_b32 v255, 0xffff0000, v217
  v_add_f32 v253, v253, v254
  v_add_f32 v253, v253, v255
  v_lshlrev_b32 v254, 16, v218
  v_and_b32 v255, 0xffff0000, v218
  v_add_f32 v253, v253, v254
  v_add_f32 v253, v253, v255
  v_lshlrev_b32 v254, 16, v219
  v_and_b32 v255, 0xffff0000, v219
  v_add_f32 v253, v253, v254
  v_add_f32 v253, v253, v255
  s_waitcnt lgkmcnt(0)
  v_mfma_f32_16x16x32_bf16 v[220:223], v[176:179], v[216:219], v[220:223]
  v_mfma_f32_16x16x32_bf16 v[224:227], v[180:183], v[216:219], v[224:227]
  v_mfma_f32_16x16x32_bf16 v[228:231], v[184:187], v[216:219], v[228:231]
  v_mfma_f32_16x16x32_bf16 v[232:235], v[188:191], v[216:219], v[232:235]
  v_mfma_f32_16x16x32_bf16 v[236:239], v[192:195], v[216:219], v[236:239]
  v_mfma_f32_16x16x32_bf16 v[240:243], v[196:199], v[216:219], v[240:243]
  v_mfma_f32_16x16x32_bf16 v[244:247], v[200:203], v[216:219], v[244:247]
  v_mfma_f32_16x16x32_bf16 v[248:251], v[204:207], v[216:219], v[248:251]
  s_nop 7
  s_nop 1
  s_add_u32 s6, s6, 8192
  s_add_u32 s5, s5, 1
  s_cmp_lt_u32 s5, 16
  s_cbranch_scc1 L_sl_t
  v_mov_b32 v255, v253
  s_nop 1
  v_permlane32_swap_b32 v255, v253
  v_add_f32 v253, v253, v255
  v_mov_b32 v255, v253
  s_nop 1
  v_permlane16_swap_b32 v255, v253
  v_add_f32 v253, v253, v255
  v_rcp_f32 v253, v253
  s_nop 0
  v_mul_f32 v220, v220, v253
  v_mul_f32 v221, v221, v253
  v_mul_f32 v222, v222, v253
  v_mul_f32 v223, v223, v253
  v_mul_f32 v224, v224, v253
  v_mul_f32 v225, v225, v253
  v_mul_f32 v226, v226, v253
  v_mul_f32 v227, v227, v253
  v_mul_f32 v228, v228, v253
  v_mul_f32 v229, v229, v253
  v_mul_f32 v230, v230, v253
  v_mul_f32 v231, v231, v253
  v_mul_f32 v232, v232, v253
  v_mul_f32 v233, v233, v253
  v_mul_f32 v234, v234, v253
  v_mul_f32 v235, v235, v253
  v_mul_f32 v236, v236, v253
  v_mul_f32 v237, v237, v253
  v_mul_f32 v238, v238, v253
  v_mul_f32 v239, v239, v253
  v_mul_f32 v240, v240, v253
  v_mul_f32 v241, v241, v253
  v_mul_f32 v242, v242, v253
  v_mul_f32 v243, v243, v253
  v_mul_f32 v244, v244, v253
  v_mul_f32 v245, v245, v253
  v_mul_f32 v246, v246, v253
  v_mul_f32 v247, v247, v253
  v_mul_f32 v248, v248, v253
  v_mul_f32 v249, v249, v253
  v_mul_f32 v250, v250, v253
  v_mul_f32 v251, v251, v253
  v_cvt_pk_bf16_f32 v144, v220, v221
  v_cvt_pk_bf16_f32 v145, v222, v223
  v_cvt_pk_bf16_f32 v146, v224, v225
  v_cvt_pk_bf16_f32 v147, v226, v227
  v_cvt_pk_bf16_f32 v148, v228, v229
  v_cvt_pk_bf16_f32 v149, v230, v231
  v_cvt_pk_bf16_f32 v150, v232, v233
  v_cvt_pk_bf16_f32 v151, v234, v235
  v_cvt_pk_bf16_f32 v152, v236, v237
  v_cvt_pk_bf16_f32 v153, v238, v239
  v_cvt_pk_bf16_f32 v154, v240, v241
  v_cvt_pk_bf16_f32 v155, v242, v243
  v_cvt_pk_bf16_f32 v156, v244, v245
  v_cvt_pk_bf16_f32 v157, v246, v247
  v_cvt_pk_bf16_f32 v158, v248, v249
  v_cvt_pk_bf16_f32 v159, v250, v251
  buffer_store_dwordx2 v[144:145], v110, s[24:27], s7 offen offset:0
  buffer_store_dwordx2 v[146:147], v110, s[24:27], s7 offen offset:32
  buffer_store_dwordx2 v[148:149], v110, s[24:27], s7 offen offset:64
  buffer_store_dwordx2 v[150:151], v110, s[24:27], s7 offen offset:96
  buffer_store_dwordx2 v[152:153], v110, s[24:27], s7 offen offset:128
  buffer_store_dwordx2 v[154:155], v110, s[24:27], s7 offen offset:160
  buffer_store_dwordx2 v[156:157], v110, s[24:27], s7 offen offset:192
  buffer_store_dwordx2 v[158:159], v110, s[24:27], s7 offen offset:224
  s_waitcnt vmcnt(0)
  s_add_u32 s7, s7, 4096
  s_add_u32 s4, s4, 1
  s_cmp_lt_u32 s4, 4
  s_cbranch_scc1 L_sl_g
  s_add_u32 s11, s9, 0
  buffer_load_dwordx4 v[96:99], v19, s[36:39], s11 offen offset:0
  buffer_load_dwordx4 v[100:103], v19, s[36:39], s11 offen offset:1024
  buffer_load_dwordx4 v[104:107], v19, s[36:39], s11 offen offset:2048
  buffer_load_dwordx4 v[108:111], v19, s[36:39], s11 offen offset:3072
  s_add_u32 s11, s9, 4096
  buffer_load_dwordx4 v[112:115], v19, s[36:39], s11 offen offset:0
  buffer_load_dwordx4 v[116:119], v19, s[36:39], s11 offen offset:1024
  buffer_load_dwordx4 v[120:123], v19, s[36:39], s11 offen offset:2048
  buffer_load_dwordx4 v[124:127], v19, s[36:39], s11 offen offset:3072
  s_add_u32 s11, s9, 8192
  buffer_load_dwordx4 v[128:131], v19, s[36:39], s11 offen offset:0
  buffer_load_dwordx4 v[132:135], v19, s[36:39], s11 offen offset:1024
  buffer_load_dwordx4 v[136:139], v19, s[36:39], s11 offen offset:2048
  buffer_load_dwordx4 v[140:143], v19, s[36:39], s11 offen offset:3072
  s_add_u32 s11, s9, 12288
  buffer_load_dwordx4 v[144:147], v19, s[36:39], s11 offen offset:0
  buffer_load_dwordx4 v[148:151], v19, s[36:39], s11 offen offset:1024
  buffer_load_dwordx4 v[152:155], v19, s[36:39], s11 offen offset:2048
  buffer_load_dwordx4 v[156:159], v19, s[36:39], s11 offen offset:3072
  s_add_u32 s11, s9, 65536
  buffer_load_dwordx4 v[160:163], v19, s[36:39], s11 offen offset:0
  buffer_load_dwordx4 v[164:167], v19, s[36:39], s11 offen offset:1024
  buffer_load_dwordx4 v[168:171], v19, s[36:39], s11 offen offset:2048
  buffer_load_dwordx4 v[172:175], v19, s[36:39], s11 offen offset:3072
  s_add_u32 s11, s9, 69632
  buffer_load_dwordx4 v[176:179], v19, s[36:39], s11 offen offset:0
  buffer_load_dwordx4 v[180:183], v19, s[36:39], s11 offen offset:1024
  buffer_load_dwordx4 v[184:187], v19, s[36:39], s11 offen offset:2048
  buffer_load_dwordx4 v[188:191], v19, s[36:39], s11 offen offset:3072
  s_add_u32 s11, s9, 73728
  buffer_load_dwordx4 v[192:195], v19, s[36:39], s11 offen offset:0
  buffer_load_dwordx4 v[196:199], v19, s[36:39], s11 offen offset:1024
  buffer_load_dwordx4 v[200:203], v19, s[36:39], s11 offen offset:2048
  buffer_load_dwordx4 v[204:207], v19, s[36:39], s11 offen offset:3072
  s_add_u32 s11, s9, 77824
  buffer_load_dwordx4 v[208:211], v19, s[36:39], s11 offen offset:0
  buffer_load_dwordx4 v[212:215], v19, s[36:39], s11 offen offset:1024
  buffer_load_dwordx4 v[216:219], v19, s[36:39], s11 offen offset:2048
  buffer_load_dwordx4 v[220:223], v19, s[36:39], s11 offen offset:3072
  s_add_u32 s11, s9, 131072
  buffer_load_dwordx4 v[224:227], v19, s[36:39], s11 offen offset:0
  buffer_load_dwordx4 v[228:231], v19, s[36:39], s11 offen offset:1024
  buffer_load_dwordx4 v[232:235], v19, s[36:39], s11 offen offset:2048
  buffer_load_dwordx4 v[236:239], v19, s[36:39], s11 offen offset:3072
  s_add_u32 s11, s9, 135168
  buffer_load_dwordx4 v[240:243], v19, s[36:39], s11 offen offset:0
  buffer_load_dwordx4 v[244:247], v19, s[36:39], s11 offen offset:1024
  buffer_load_dwordx4 v[248:251], v19, s[36:39], s11 offen offset:2048
  buffer_load_dwordx4 v[252:255], v19, s[36:39], s11 offen offset:3072
  s_waitcnt vmcnt(0)
  s_mov_b32 m0, s8
  s_cmp_eq_u32 s10, 0
  s_cbranch_scc1 L_ret0
  s_branch L_ret1
.section .rodata,"a"
.p2align 6
.amdhsa_kernel standalone__mha_softmax__near_ridge_kernel
  .amdhsa_next_free_vgpr 512
  .amdhsa_next_free_sgpr 102
  .amdhsa_accum_offset 256
  .amdhsa_group_segment_fixed_size 0
  .amdhsa_kernarg_size 48
  .amdhsa_user_sgpr_count 2
  .amdhsa_user_sgpr_kernarg_segment_ptr 1
  .amdhsa_system_sgpr_workgroup_id_x 1
.end_amdhsa_kernel
```
